```python
import torch

def _softmax(x, axis=-1):
    return torch.softmax(x, dim=axis)
def _gelu(x):
    return torch.nn.functional.gelu(x, approximate="tanh")
def _silu(x):
    return torch.nn.functional.silu(x)
def _sigmoid(x):
    return torch.sigmoid(x)
def _layernorm(x, axis=-1, eps=1e-5):
    m = x.mean(dim=axis, keepdim=True)
    v = x.var(dim=axis, keepdim=True, unbiased=False)
    return (x - m) / torch.sqrt(v + eps)
def _scatter_add(tgt, idx, src, axis=0):
    return tgt.clone().index_add_(axis, idx, src)
def _segment_sum(src, seg, n):
    out = torch.zeros((n,) + src.shape[1:], dtype=src.dtype)
    return out.index_add_(0, seg, src)
def _pad(x, pw):
    flat = tuple(v for pair in reversed(pw) for v in pair)
    return torch.nn.functional.pad(x, flat)

kernel_name = 'gather_scatter__molecular_angular_gemnet__graph'

def setup_inputs():

    _w = (lambda a: (lambda t: t.to(torch.bfloat16) if t.is_floating_point() else t)(torch.as_tensor(a)))
    N, deg, De, L = 10000, 16, 4, 1
    E = N * deg
    T = E * deg
    NR = 8
    dist = torch.rand(E).to(float)
    angle = (torch.rand(T) * torch.pi).to(float)
    centers = torch.linspace(0.0, 1.0, NR).to(float)
    ang_freq = torch.arange(1, L + 1).to(float)
    return {
        "m": _w((lambda *s: torch.randn(*s, dtype=torch.bfloat16) * 0.05)(E, De)),
        "idx_in": _w((lambda lo, hi, *s: torch.randint(lo, hi, s))(0, E, T).to(torch.int64)),
        "idx_out": _w((lambda lo, hi, *s: torch.randint(lo, hi, s))(0, E, T).to(torch.int64)),
        "dist": _w(dist),
        "angle": _w(angle),
        "centers": _w(centers),
        "ang_freq": _w(ang_freq),
        "w_rbf": _w((lambda *s: torch.randn(*s, dtype=torch.bfloat16) * 0.4)(NR, De)),
        "w_sbf": _w((lambda *s: torch.randn(*s, dtype=torch.bfloat16) * 0.4)(NR * L, De)),
        "w_down": _w((lambda *s: torch.randn(*s, dtype=torch.bfloat16) * 0.4)(De, De)),
        "w_up": _w((lambda *s: torch.randn(*s, dtype=torch.bfloat16) * 0.4)(De, De)),
    }

def reference(m, idx_in, idx_out, dist, angle, centers, ang_freq, w_rbf, w_sbf, w_down, w_up):
    E, De = m.shape[0], m.shape[1]
    NR = centers.shape[0]
    L = ang_freq.shape[0]
    rbf = torch.exp(-10.0 * (dist[:, None] - centers[None, :]) ** 2)
    cbf = torch.cos(ang_freq[None, :] * angle[:, None])
    rbf_t = rbf[idx_out]
    sbf = torch.reshape(rbf_t[:, :, None] * cbf[:, None, :], (-1, NR * L))
    x = (m[idx_in] @ w_down) * (sbf @ w_sbf)
    agg = _segment_sum(x, idx_out, E)
    return m + (agg @ w_up) * (rbf @ w_rbf)
```

```asm
; @launch kernel=part_kernel grid=(250,1,1) block=(1024,1,1) lds=63488
; @launch kernel=acc_kernel grid=(256,1,1) block=(1024,1,1) lds=97792
.amdgcn_target "amdgcn-amd-amdhsa--gfx950"
.text
.globl part_kernel
.p2align 8
.type part_kernel,@function
part_kernel:
  s_cmp_ge_u32 s2, 250
  s_cbranch_scc1 L_part_end
  s_load_dwordx4 s[4:7], s[0:1], 8
  s_load_dwordx2 s[8:9], s[0:1], 32
  s_load_dwordx2 s[10:11], s[0:1], 48
  s_load_dwordx2 s[12:13], s[0:1], 104
  v_lshlrev_b32 v1, 4, v0
  v_lshlrev_b32 v2, 3, v0
  v_lshlrev_b32 v3, 2, v0
  v_mov_b32 v4, 0
  v_mov_b32 v5, 1
  ds_write_b32 v3, v4
  v_readfirstlane_b32 s38, v0
  s_mul_i32 s32, s2, 40960
  s_add_u32 s33, s32, 16384
  s_add_u32 s34, s32, 32768
  s_mul_i32 s35, s2, 20480
  s_add_u32 s36, s35, 8192
  s_add_u32 s37, s35, 16384
  s_lshr_b32 s38, s38, 6
  s_movk_i32 s40, -625
  s_waitcnt lgkmcnt(0)
  s_mov_b32 s16, s6
  s_and_b32 s17, s7, 0xffff
  s_mov_b32 s18, 10240000
  s_mov_b32 s19, 0x20000
  s_mov_b32 s20, s4
  s_and_b32 s21, s5, 0xffff
  s_mov_b32 s22, 10240000
  s_mov_b32 s23, 0x20000
  s_mov_b32 s24, s8
  s_and_b32 s25, s9, 0xffff
  s_mov_b32 s26, 5120000
  s_mov_b32 s27, 0x20000
  s_load_dword s39, s[10:11], 0
  buffer_load_dwordx4 v[8:11], v1, s[16:19], s32 offen nt
  buffer_load_dwordx4 v[12:15], v1, s[16:19], s33 offen nt
  buffer_load_dwordx2 v[16:17], v2, s[16:19], s34 offen nt
  s_mov_b32 s28, s12
  s_and_b32 s29, s13, 0xffff
  s_mov_b32 s30, 33816576
  s_mov_b32 s31, 0x20000
  s_barrier
  buffer_load_dwordx4 v[20:23], v1, s[20:23], s32 offen nt
  buffer_load_dwordx4 v[24:27], v1, s[20:23], s33 offen nt
  buffer_load_dwordx2 v[28:29], v2, s[20:23], s34 offen nt
  s_waitcnt vmcnt(5)
  v_mul_hi_u32_u24 v6, 0x68db8c, v8
  v_mad_i32_i24 v36, v6, s40, v8
  v_lshlrev_b32 v8, 2, v6
  ds_add_rtn_u32 v46, v8, v5
  v_mul_hi_u32_u24 v6, 0x68db8c, v9
  v_mad_i32_i24 v37, v6, s40, v9
  v_lshlrev_b32 v9, 2, v6
  ds_add_rtn_u32 v47, v9, v5
  v_mul_hi_u32_u24 v6, 0x68db8c, v10
  v_mad_i32_i24 v38, v6, s40, v10
  v_lshlrev_b32 v10, 2, v6
  ds_add_rtn_u32 v48, v10, v5
  v_mul_hi_u32_u24 v6, 0x68db8c, v11
  v_mad_i32_i24 v39, v6, s40, v11
  v_lshlrev_b32 v11, 2, v6
  ds_add_rtn_u32 v49, v11, v5
  s_waitcnt vmcnt(4)
  v_mul_hi_u32_u24 v6, 0x68db8c, v12
  v_mad_i32_i24 v40, v6, s40, v12
  v_lshlrev_b32 v12, 2, v6
  ds_add_rtn_u32 v50, v12, v5
  v_mul_hi_u32_u24 v6, 0x68db8c, v13
  v_mad_i32_i24 v41, v6, s40, v13
  v_lshlrev_b32 v13, 2, v6
  ds_add_rtn_u32 v51, v13, v5
  v_mul_hi_u32_u24 v6, 0x68db8c, v14
  v_mad_i32_i24 v42, v6, s40, v14
  v_lshlrev_b32 v14, 2, v6
  ds_add_rtn_u32 v52, v14, v5
  v_mul_hi_u32_u24 v6, 0x68db8c, v15
  v_mad_i32_i24 v43, v6, s40, v15
  v_lshlrev_b32 v15, 2, v6
  ds_add_rtn_u32 v53, v15, v5
  s_waitcnt vmcnt(3)
  v_mul_hi_u32_u24 v6, 0x68db8c, v16
  v_mad_i32_i24 v44, v6, s40, v16
  v_lshlrev_b32 v16, 2, v6
  ds_add_rtn_u32 v54, v16, v5
  v_mul_hi_u32_u24 v6, 0x68db8c, v17
  v_mad_i32_i24 v45, v6, s40, v17
  v_lshlrev_b32 v17, 2, v6
  ds_add_rtn_u32 v55, v17, v5
  buffer_load_dwordx2 v[30:31], v2, s[24:27], s35 offen nt
  buffer_load_dwordx2 v[32:33], v2, s[24:27], s36 offen nt
  buffer_load_dword v34, v3, s[24:27], s37 offen nt
  s_waitcnt lgkmcnt(0)
  s_barrier
  s_cmp_lg_u32 s38, 0
  s_cbranch_scc1 L_part_noscan
  ds_read_b128 v[56:59], v1
  s_waitcnt lgkmcnt(0)
  v_add_u32 v60, v56, v57
  v_add_u32 v61, v60, v58
  v_add_u32 v62, v61, v59
  v_mov_b32 v63, v62
  s_nop 1
  v_add_u32_dpp v63, v63, v63 row_shr:1 row_mask:0xf bank_mask:0xf bound_ctrl:0
  s_nop 1
  v_add_u32_dpp v63, v63, v63 row_shr:2 row_mask:0xf bank_mask:0xf bound_ctrl:0
  s_nop 1
  v_add_u32_dpp v63, v63, v63 row_shr:4 row_mask:0xf bank_mask:0xf bound_ctrl:0
  s_nop 1
  v_add_u32_dpp v63, v63, v63 row_shr:8 row_mask:0xf bank_mask:0xf bound_ctrl:0
  s_nop 1
  v_add_u32_dpp v63, v63, v63 row_bcast:15 row_mask:0xa bank_mask:0xf
  s_nop 1
  v_add_u32_dpp v63, v63, v63 row_bcast:31 row_mask:0xc bank_mask:0xf
  v_sub_u32 v64, v63, v62
  v_add_u32 v65, v64, v56
  v_add_u32 v66, v64, v60
  v_add_u32 v67, v64, v61
  ds_write_b128 v1, v[64:67] offset:1024
  v_lshl_or_b32 v72, v56, 16, v64
  v_lshl_or_b32 v73, v57, 16, v65
  v_lshl_or_b32 v74, v58, 16, v66
  v_lshl_or_b32 v75, v59, 16, v67
  s_lshl_b32 s41, s2, 10
  s_add_u32 s41, s41, 0x2000000
  buffer_store_dwordx4 v[72:75], v1, s[28:31], s41 offen sc0 sc1
  s_waitcnt lgkmcnt(0)
L_part_noscan:
  s_barrier
  ds_read_b32 v56, v8 offset:1024
  ds_read_b32 v57, v9 offset:1024
  ds_read_b32 v58, v10 offset:1024
  ds_read_b32 v59, v11 offset:1024
  ds_read_b32 v60, v12 offset:1024
  ds_read_b32 v61, v13 offset:1024
  ds_read_b32 v62, v14 offset:1024
  ds_read_b32 v63, v15 offset:1024
  ds_read_b32 v64, v16 offset:1024
  ds_read_b32 v65, v17 offset:1024
  s_lshl_b32 s39, s39, 16
  v_mov_b32 v7, s39
  v_mul_f32 v7, 0.15915494, v7
  s_waitcnt vmcnt(5)
  v_lshlrev_b32 v20, 3, v20
  v_lshl_or_b32 v20, v36, 21, v20
  v_lshlrev_b32 v21, 3, v21
  v_lshl_or_b32 v21, v37, 21, v21
  v_lshlrev_b32 v22, 3, v22
  v_lshl_or_b32 v22, v38, 21, v22
  v_lshlrev_b32 v23, 3, v23
  v_lshl_or_b32 v23, v39, 21, v23
  s_waitcnt vmcnt(4)
  v_lshlrev_b32 v24, 3, v24
  v_lshl_or_b32 v24, v40, 21, v24
  v_lshlrev_b32 v25, 3, v25
  v_lshl_or_b32 v25, v41, 21, v25
  v_lshlrev_b32 v26, 3, v26
  v_lshl_or_b32 v26, v42, 21, v26
  v_lshlrev_b32 v27, 3, v27
  v_lshl_or_b32 v27, v43, 21, v27
  s_waitcnt vmcnt(3)
  v_lshlrev_b32 v28, 3, v28
  v_lshl_or_b32 v28, v44, 21, v28
  v_lshlrev_b32 v29, 3, v29
  v_lshl_or_b32 v29, v45, 21, v29
  s_waitcnt lgkmcnt(0)
  v_add_u32 v56, v56, v46
  v_lshlrev_b32 v46, 2, v56
  v_lshlrev_b32 v56, 1, v56
  ds_write_b32 v46, v20 offset:2048
  v_add_u32 v57, v57, v47
  v_lshlrev_b32 v47, 2, v57
  v_lshlrev_b32 v57, 1, v57
  ds_write_b32 v47, v21 offset:2048
  v_add_u32 v58, v58, v48
  v_lshlrev_b32 v48, 2, v58
  v_lshlrev_b32 v58, 1, v58
  ds_write_b32 v48, v22 offset:2048
  v_add_u32 v59, v59, v49
  v_lshlrev_b32 v49, 2, v59
  v_lshlrev_b32 v59, 1, v59
  ds_write_b32 v49, v23 offset:2048
  v_add_u32 v60, v60, v50
  v_lshlrev_b32 v50, 2, v60
  v_lshlrev_b32 v60, 1, v60
  ds_write_b32 v50, v24 offset:2048
  v_add_u32 v61, v61, v51
  v_lshlrev_b32 v51, 2, v61
  v_lshlrev_b32 v61, 1, v61
  ds_write_b32 v51, v25 offset:2048
  v_add_u32 v62, v62, v52
  v_lshlrev_b32 v52, 2, v62
  v_lshlrev_b32 v62, 1, v62
  ds_write_b32 v52, v26 offset:2048
  v_add_u32 v63, v63, v53
  v_lshlrev_b32 v53, 2, v63
  v_lshlrev_b32 v63, 1, v63
  ds_write_b32 v53, v27 offset:2048
  v_add_u32 v64, v64, v54
  v_lshlrev_b32 v54, 2, v64
  v_lshlrev_b32 v64, 1, v64
  ds_write_b32 v54, v28 offset:2048
  v_add_u32 v65, v65, v55
  v_lshlrev_b32 v55, 2, v65
  v_lshlrev_b32 v65, 1, v65
  ds_write_b32 v55, v29 offset:2048
  s_mul_i32 s42, s2, 40960
  s_add_u32 s43, s42, 16384
  s_add_u32 s44, s42, 32768
  s_mul_i32 s45, s2, 20480
  s_add_u32 s45, s45, 0x1000000
  s_add_u32 s47, s45, 16384
  v_mov_b32 v68, 0x7fffff00
  v_cmp_gt_u32 vcc, 256, v0
  s_mov_b64 s[48:49], vcc
  v_cmp_gt_u32 vcc, 512, v0
  s_waitcnt lgkmcnt(0)
  s_barrier
  ds_read_b128 v[8:11], v1 offset:2048
  ds_read_b128 v[12:15], v1 offset:18432
  ds_read_b128 v[16:19], v1 offset:34816
  v_cndmask_b32 v69, v68, v1, vcc
  v_cndmask_b32 v68, v68, v1, s[48:49]
  s_waitcnt lgkmcnt(2)
  buffer_store_dwordx4 v[8:11], v1, s[28:31], s42 offen sc0 sc1
  s_waitcnt lgkmcnt(1)
  buffer_store_dwordx4 v[12:15], v1, s[28:31], s43 offen sc0 sc1
  s_waitcnt lgkmcnt(0)
  buffer_store_dwordx4 v[16:19], v69, s[28:31], s44 offen sc0 sc1
  s_waitcnt vmcnt(5)
  v_lshlrev_b32 v6, 16, v30
  v_and_b32 v66, 0xffff0000, v30
  v_mul_f32 v6, v7, v6
  v_mul_f32 v66, v7, v66
  v_fract_f32 v6, v6
  v_fract_f32 v66, v66
  v_cos_f32 v6, v6
  v_cos_f32 v66, v66
  s_nop 0
  v_cvt_pk_bf16_f32 v30, v6, v66
  ds_write_b16 v56, v30 offset:43008
  ds_write_b16_d16_hi v57, v30 offset:43008
  v_lshlrev_b32 v6, 16, v31
  v_and_b32 v66, 0xffff0000, v31
  v_mul_f32 v6, v7, v6
  v_mul_f32 v66, v7, v66
  v_fract_f32 v6, v6
  v_fract_f32 v66, v66
  v_cos_f32 v6, v6
  v_cos_f32 v66, v66
  s_nop 0
  v_cvt_pk_bf16_f32 v31, v6, v66
  ds_write_b16 v58, v31 offset:43008
  ds_write_b16_d16_hi v59, v31 offset:43008
  s_waitcnt vmcnt(4)
  v_lshlrev_b32 v6, 16, v32
  v_and_b32 v66, 0xffff0000, v32
  v_mul_f32 v6, v7, v6
  v_mul_f32 v66, v7, v66
  v_fract_f32 v6, v6
  v_fract_f32 v66, v66
  v_cos_f32 v6, v6
  v_cos_f32 v66, v66
  s_nop 0
  v_cvt_pk_bf16_f32 v32, v6, v66
  ds_write_b16 v60, v32 offset:43008
  ds_write_b16_d16_hi v61, v32 offset:43008
  v_lshlrev_b32 v6, 16, v33
  v_and_b32 v66, 0xffff0000, v33
  v_mul_f32 v6, v7, v6
  v_mul_f32 v66, v7, v66
  v_fract_f32 v6, v6
  v_fract_f32 v66, v66
  v_cos_f32 v6, v6
  v_cos_f32 v66, v66
  s_nop 0
  v_cvt_pk_bf16_f32 v33, v6, v66
  ds_write_b16 v62, v33 offset:43008
  ds_write_b16_d16_hi v63, v33 offset:43008
  s_waitcnt vmcnt(3)
  v_lshlrev_b32 v6, 16, v34
  v_and_b32 v66, 0xffff0000, v34
  v_mul_f32 v6, v7, v6
  v_mul_f32 v66, v7, v66
  v_fract_f32 v6, v6
  v_fract_f32 v66, v66
  v_cos_f32 v6, v6
  v_cos_f32 v66, v66
  s_nop 0
  v_cvt_pk_bf16_f32 v34, v6, v66
  ds_write_b16 v64, v34 offset:43008
  ds_write_b16_d16_hi v65, v34 offset:43008
  s_waitcnt lgkmcnt(0)
  s_barrier
  ds_read_b128 v[20:23], v1 offset:43008
  ds_read_b128 v[24:27], v1 offset:59392
  s_waitcnt lgkmcnt(1)
  buffer_store_dwordx4 v[20:23], v1, s[28:31], s45 offen sc0 sc1
  s_waitcnt lgkmcnt(0)
  buffer_store_dwordx4 v[24:27], v68, s[28:31], s47 offen sc0 sc1
L_part_end:
  s_endpgm
.globl acc_kernel
.p2align 8
.type acc_kernel,@function
acc_kernel:
  s_cmp_ge_u32 s2, 256
  s_cbranch_scc1 L_acc_end
  s_and_b32 s3, s2, 7
  s_lshr_b32 s2, s2, 3
  s_mul_i32 s3, s3, 32
  s_add_u32 s2, s2, s3
  s_load_dwordx2 s[52:53], s[0:1], 104
  s_load_dwordx2 s[54:55], s[0:1], 0
  s_load_dwordx2 s[56:57], s[0:1], 24
  s_load_dwordx2 s[58:59], s[0:1], 88
  s_load_dwordx2 s[60:61], s[0:1], 40
  s_load_dwordx4 s[64:67], s[0:1], 56
  s_load_dwordx4 s[68:71], s[0:1], 72
  s_setprio 3
  v_and_b32 v1, 63, v0
  v_readfirstlane_b32 s96, v0
  v_and_b32 v4, 3, v0
  v_lshlrev_b32 v5, 3, v4
  v_lshlrev_b32 v4, 1, v4
  s_lshr_b32 s96, s96, 6
  s_lshl_b32 s97, s2, 2
  s_lshl_b32 s99, s96, 4
  v_lshrrev_b32 v2, 4, v1
  v_add_u32 v2, s99, v2
  v_and_b32 v3, 15, v1
  v_lshlrev_b32 v3, 2, v3
  v_lshlrev_b32 v72, 10, v2
  v_add_u32 v73, 4096, v72
  v_add_u32 v74, 8192, v72
  v_add_u32 v75, 12288, v72
  s_waitcnt lgkmcnt(0)
  s_add_u32 s88, s52, 0x2000000
  s_addc_u32 s89, s53, 0
  s_and_b32 s89, s89, 0xffff
  s_mov_b32 s90, 256000
  s_mov_b32 s91, 0x20000
  buffer_load_dword v44, v72, s[88:91], s97 offen
  buffer_load_dword v45, v73, s[88:91], s97 offen
  buffer_load_dword v46, v74, s[88:91], s97 offen
  buffer_load_dword v47, v75, s[88:91], s97 offen
  s_mov_b32 s4, s52
  s_and_b32 s5, s53, 0xffff
  s_mov_b32 s6, 10240000
  s_mov_b32 s7, 0x20000
  s_add_u32 s8, s52, 0x1000000
  s_addc_u32 s9, s53, 0
  s_and_b32 s9, s9, 0xffff
  s_mov_b32 s10, 5120016
  s_mov_b32 s11, 0x20000
  s_mov_b32 s12, s54
  s_and_b32 s13, s55, 0xffff
  s_mov_b32 s14, 1280000
  s_mov_b32 s15, 0x20000
  s_mov_b32 s16, s58
  s_and_b32 s17, s59, 0xffff
  s_mov_b32 s18, 1280000
  s_mov_b32 s19, 0x20000
  s_mov_b32 s92, s56
  s_and_b32 s93, s57, 0xffff
  s_mov_b32 s94, 320000
  s_mov_b32 s95, 0x20000
  s_mul_i32 s97, s2, 625
  s_sub_u32 s97, s97, 384
  v_add_u32 v73, s97, v0
  v_lshlrev_b32 v74, 1, v73
  v_lshlrev_b32 v75, 3, v73
  s_cmp_lt_u32 s96, 6
  s_cbranch_scc1 L_acc_nofin0
  buffer_load_ushort v9, v74, s[92:95], 0 offen
  buffer_load_dwordx2 v[10:11], v75, s[12:15], 0 offen
  s_load_dwordx16 s[72:87], s[66:67], 0
  s_load_dwordx8 s[20:27], s[68:69], 0
  s_load_dwordx8 s[36:43], s[70:71], 0
  s_load_dwordx4 s[68:71], s[60:61], 0
  s_load_dwordx16 s[52:67], s[64:65], 0
L_acc_nofin0:
  v_lshlrev_b32 v68, 24, v4
  v_lshl_or_b32 v68, v4, 16, v68
  v_add_u32 v68, 0x01000c0c, v68
  v_mov_b32 v69, 0x7fffff00
  v_mov_b32 v6, 1
  v_mul_u32_u24 v2, 40960, v2
  s_mov_b32 s98, 0
  s_cmp_lt_u32 s96, 6
  s_cbranch_scc1 L_acc_w0
  s_waitcnt vmcnt(2)
  s_branch L_acc_w1
L_acc_w0:
  s_waitcnt vmcnt(0)
L_acc_w1:
  v_and_b32 v70, 0xffff, v44
  v_lshrrev_b32 v44, 16, v44
  v_lshl_add_u32 v48, v70, 2, v2
  v_and_b32 v70, 0xffff, v45
  v_lshrrev_b32 v45, 16, v45
  v_lshl_add_u32 v49, v70, 2, v2
  v_add_u32 v49, 163840, v49
  v_and_b32 v70, 0xffff, v46
  v_lshrrev_b32 v46, 16, v46
  v_lshl_add_u32 v50, v70, 2, v2
  v_add_u32 v50, 327680, v50
  v_and_b32 v70, 0xffff, v47
  v_lshrrev_b32 v47, 16, v47
  v_lshl_add_u32 v51, v70, 2, v2
  v_add_u32 v51, 491520, v51
  s_cmp_ge_u32 s96, 6
  s_cbranch_scc1 L_bin_round
L_dir_round:
  v_min_u32 v70, 64, v44
  v_sub_u32 v52, v70, v3
  v_lshl_add_u32 v72, v3, 2, v48
  v_cmp_lt_i32 s[88:89], 0, v52
  v_min_u32 v70, 64, v45
  v_sub_u32 v53, v70, v3
  v_lshl_add_u32 v73, v3, 2, v49
  v_cmp_lt_i32 s[90:91], 0, v53
  v_min_u32 v70, 64, v46
  v_sub_u32 v54, v70, v3
  v_lshl_add_u32 v74, v3, 2, v50
  v_cmp_lt_i32 s[92:93], 0, v54
  v_min_u32 v70, 64, v47
  v_sub_u32 v55, v70, v3
  v_lshl_add_u32 v75, v3, 2, v51
  v_cmp_lt_i32 s[94:95], 0, v55
  s_nop 0
  v_cndmask_b32 v92, v69, v72, s[88:89]
  v_cndmask_b32 v93, v69, v73, s[90:91]
  v_cndmask_b32 v94, v69, v74, s[92:93]
  v_cndmask_b32 v66, v69, v75, s[94:95]
  v_lshrrev_b32 v67, 1, v92
  buffer_load_dwordx4 v[20:23], v92, s[4:7], 0 offen
  buffer_load_dwordx2 v[36:37], v67, s[8:11], 0 offen
L_dir_issued:
  s_setprio 0
  s_cmp_lg_u32 s98, 0
  s_cbranch_scc1 L_dir_noinit
  v_lshlrev_b32 v70, 4, v0
  v_mov_b32 v76, 0
  v_mov_b32 v77, 0
  v_mov_b32 v78, 0
  v_mov_b32 v79, 0
  v_mov_b32 v80, -1
  v_mov_b32 v81, -1
  v_mov_b32 v82, -1
  v_mov_b32 v83, -1
  ds_write_b128 v70, v[76:79]
  ds_write_b128 v70, v[76:79] offset:16384
  v_add_u32 v71, 47616, v70
  ds_write_b128 v71, v[80:83]
  ds_write_b128 v71, v[80:83] offset:16384
  ds_write_b128 v71, v[80:83] offset:32768
  ds_write_b128 v71, v[80:83] offset:49152
L_dir_noinit:
  s_waitcnt vmcnt(1)
  v_cmp_lt_i32 s[88:89], 0, v52
  v_cmp_lt_i32 s[90:91], 1, v52
  v_cmp_lt_i32 s[92:93], 2, v52
  v_cmp_lt_i32 s[94:95], 3, v52
  v_cndmask_b32 v20, -1, v20, s[88:89]
  v_cndmask_b32 v21, -1, v21, s[90:91]
  v_cndmask_b32 v22, -1, v22, s[92:93]
  v_cndmask_b32 v23, -1, v23, s[94:95]
  v_and_b32 v70, 0x1fffff, v20
  v_ashrrev_i32 v20, 16, v20
  buffer_load_dwordx2 v[96:97], v70, s[12:15], 0 offen
  v_and_b32 v20, 0x8000ffe0, v20
  s_mov_b32 s99, s98
  s_cmp_lg_u32 s98, 0
  s_cbranch_scc1 L_dir_nobar
  s_waitcnt lgkmcnt(0)
  s_barrier
  s_mov_b32 s98, 1
L_dir_nobar:
  v_max_u32 v70, v44, v45
  v_max3_u32 v70, v70, v46, v47
  v_cmp_lt_u32 vcc, 64, v70
  s_nop 1
  s_cmp_eq_u64 vcc, 0
  s_cbranch_scc1 L_dir_nospare
  v_mov_b32 v56, 0
  v_mov_b32 v57, 0
  v_mov_b32 v58, -1
  v_cmp_lt_u32 vcc, 64, v47
  v_subrev_u32 v70, 64, v47
  v_add_u32 v71, 256, v51
  v_cndmask_b32 v56, v56, v70, vcc
  v_cndmask_b32 v57, v57, v71, vcc
  v_cndmask_b32 v58, v58, 3, vcc
  v_cmp_lt_u32 vcc, 64, v46
  v_subrev_u32 v70, 64, v46
  v_add_u32 v71, 256, v50
  v_cndmask_b32 v56, v56, v70, vcc
  v_cndmask_b32 v57, v57, v71, vcc
  v_cndmask_b32 v58, v58, 2, vcc
  v_cmp_lt_u32 vcc, 64, v45
  v_subrev_u32 v70, 64, v45
  v_add_u32 v71, 256, v49
  v_cndmask_b32 v56, v56, v70, vcc
  v_cndmask_b32 v57, v57, v71, vcc
  v_cndmask_b32 v58, v58, 1, vcc
  v_cmp_lt_u32 vcc, 64, v44
  v_subrev_u32 v70, 64, v44
  v_add_u32 v71, 256, v48
  v_cndmask_b32 v56, v56, v70, vcc
  v_cndmask_b32 v57, v57, v71, vcc
  v_cndmask_b32 v58, v58, 0, vcc
  v_min_u32 v56, 64, v56
  v_sub_u32 v59, v56, v3
  v_lshl_add_u32 v57, v3, 2, v57
  v_cmp_lt_i32 vcc, 0, v59
  s_nop 1
  v_cndmask_b32 v57, v69, v57, vcc
  v_lshrrev_b32 v70, 1, v57
  buffer_load_dwordx4 v[60:63], v57, s[4:7], 0 offen
  buffer_load_dwordx2 v[64:65], v70, s[8:11], 0 offen
  v_cmp_eq_u32 vcc, 0, v58
  v_lshlrev_b32 v70, 2, v56
  s_nop 0
  v_cndmask_b32 v71, 0, v70, vcc
  v_cndmask_b32 v70, 0, v56, vcc
  v_add_u32 v48, v48, v71
  v_sub_u32 v44, v44, v70
  v_cmp_eq_u32 vcc, 1, v58
  v_lshlrev_b32 v70, 2, v56
  s_nop 0
  v_cndmask_b32 v71, 0, v70, vcc
  v_cndmask_b32 v70, 0, v56, vcc
  v_add_u32 v49, v49, v71
  v_sub_u32 v45, v45, v70
  v_cmp_eq_u32 vcc, 2, v58
  v_lshlrev_b32 v70, 2, v56
  s_nop 0
  v_cndmask_b32 v71, 0, v70, vcc
  v_cndmask_b32 v70, 0, v56, vcc
  v_add_u32 v50, v50, v71
  v_sub_u32 v46, v46, v70
  v_cmp_eq_u32 vcc, 3, v58
  v_lshlrev_b32 v70, 2, v56
  s_nop 0
  v_cndmask_b32 v71, 0, v70, vcc
  v_cndmask_b32 v70, 0, v56, vcc
  v_add_u32 v51, v51, v71
  v_sub_u32 v47, v47, v70
  s_waitcnt vmcnt(0)
  v_cmp_lt_i32 s[88:89], 0, v59
  v_cmp_lt_i32 s[90:91], 1, v59
  v_cmp_lt_i32 s[92:93], 2, v59
  v_cmp_lt_i32 s[94:95], 3, v59
  v_cndmask_b32 v60, -1, v60, s[88:89]
  v_cndmask_b32 v61, -1, v61, s[90:91]
  v_cndmask_b32 v62, -1, v62, s[92:93]
  v_cndmask_b32 v63, -1, v63, s[94:95]
  v_and_b32 v70, 0x1fffff, v60
  v_ashrrev_i32 v60, 16, v60
  buffer_load_dwordx2 v[112:113], v70, s[12:15], 0 offen
  v_and_b32 v60, 0x8000ffe0, v60
  v_and_b32 v70, 0x1fffff, v61
  v_ashrrev_i32 v61, 16, v61
  buffer_load_dwordx2 v[114:115], v70, s[12:15], 0 offen
  v_and_b32 v61, 0x8000ffe0, v61
  v_and_b32 v70, 0x1fffff, v62
  v_ashrrev_i32 v62, 16, v62
  buffer_load_dwordx2 v[116:117], v70, s[12:15], 0 offen
  v_and_b32 v62, 0x8000ffe0, v62
  v_and_b32 v70, 0x1fffff, v63
  v_ashrrev_i32 v63, 16, v63
  buffer_load_dwordx2 v[118:119], v70, s[12:15], 0 offen
  v_and_b32 v63, 0x8000ffe0, v63
  s_waitcnt vmcnt(0)
  v_lshlrev_b32 v71, 16, v64
  v_mov_b32_dpp v72, v112 quad_perm:[0,0,0,0] row_mask:0xf bank_mask:0xf
  v_mov_b32_dpp v73, v112 quad_perm:[1,1,1,1] row_mask:0xf bank_mask:0xf
  v_mov_b32_dpp v74, v112 quad_perm:[2,2,2,2] row_mask:0xf bank_mask:0xf
  v_mov_b32_dpp v75, v112 quad_perm:[3,3,3,3] row_mask:0xf bank_mask:0xf
  v_mov_b32_dpp v88, v113 quad_perm:[0,0,0,0] row_mask:0xf bank_mask:0xf
  v_mov_b32_dpp v89, v113 quad_perm:[1,1,1,1] row_mask:0xf bank_mask:0xf
  v_mov_b32_dpp v90, v113 quad_perm:[2,2,2,2] row_mask:0xf bank_mask:0xf
  v_mov_b32_dpp v91, v113 quad_perm:[3,3,3,3] row_mask:0xf bank_mask:0xf
  v_perm_b32 v88, v88, v72, v68
  v_perm_b32 v89, v89, v73, v68
  v_perm_b32 v90, v90, v74, v68
  v_perm_b32 v91, v91, v75, v68
  v_add_u32_dpp v84, v60, v5 quad_perm:[0,0,0,0] row_mask:0xf bank_mask:0xf
  v_add_u32_dpp v85, v60, v5 quad_perm:[1,1,1,1] row_mask:0xf bank_mask:0xf
  v_add_u32_dpp v86, v60, v5 quad_perm:[2,2,2,2] row_mask:0xf bank_mask:0xf
  v_add_u32_dpp v87, v60, v5 quad_perm:[3,3,3,3] row_mask:0xf bank_mask:0xf
  v_mul_f32_dpp v88, v71, v88 quad_perm:[0,0,0,0] row_mask:0xf bank_mask:0xf
  v_mul_f32_dpp v89, v71, v89 quad_perm:[1,1,1,1] row_mask:0xf bank_mask:0xf
  v_mul_f32_dpp v90, v71, v90 quad_perm:[2,2,2,2] row_mask:0xf bank_mask:0xf
  v_mul_f32_dpp v91, v71, v91 quad_perm:[3,3,3,3] row_mask:0xf bank_mask:0xf
  v_cvt_f64_f32 v[76:77], v88
  v_cvt_f64_f32 v[78:79], v89
  v_cvt_f64_f32 v[80:81], v90
  v_cvt_f64_f32 v[82:83], v91
  ds_add_f64 v84, v[76:77]
  ds_add_f64 v85, v[78:79]
  ds_add_f64 v86, v[80:81]
  ds_add_f64 v87, v[82:83]
  v_and_b32 v71, 0xffff0000, v64
  v_mov_b32_dpp v72, v114 quad_perm:[0,0,0,0] row_mask:0xf bank_mask:0xf
  v_mov_b32_dpp v73, v114 quad_perm:[1,1,1,1] row_mask:0xf bank_mask:0xf
  v_mov_b32_dpp v74, v114 quad_perm:[2,2,2,2] row_mask:0xf bank_mask:0xf
  v_mov_b32_dpp v75, v114 quad_perm:[3,3,3,3] row_mask:0xf bank_mask:0xf
  v_mov_b32_dpp v88, v115 quad_perm:[0,0,0,0] row_mask:0xf bank_mask:0xf
  v_mov_b32_dpp v89, v115 quad_perm:[1,1,1,1] row_mask:0xf bank_mask:0xf
  v_mov_b32_dpp v90, v115 quad_perm:[2,2,2,2] row_mask:0xf bank_mask:0xf
  v_mov_b32_dpp v91, v115 quad_perm:[3,3,3,3] row_mask:0xf bank_mask:0xf
  v_perm_b32 v88, v88, v72, v68
  v_perm_b32 v89, v89, v73, v68
  v_perm_b32 v90, v90, v74, v68
  v_perm_b32 v91, v91, v75, v68
  v_add_u32_dpp v84, v61, v5 quad_perm:[0,0,0,0] row_mask:0xf bank_mask:0xf
  v_add_u32_dpp v85, v61, v5 quad_perm:[1,1,1,1] row_mask:0xf bank_mask:0xf
  v_add_u32_dpp v86, v61, v5 quad_perm:[2,2,2,2] row_mask:0xf bank_mask:0xf
  v_add_u32_dpp v87, v61, v5 quad_perm:[3,3,3,3] row_mask:0xf bank_mask:0xf
  v_mul_f32_dpp v88, v71, v88 quad_perm:[0,0,0,0] row_mask:0xf bank_mask:0xf
  v_mul_f32_dpp v89, v71, v89 quad_perm:[1,1,1,1] row_mask:0xf bank_mask:0xf
  v_mul_f32_dpp v90, v71, v90 quad_perm:[2,2,2,2] row_mask:0xf bank_mask:0xf
  v_mul_f32_dpp v91, v71, v91 quad_perm:[3,3,3,3] row_mask:0xf bank_mask:0xf
  v_cvt_f64_f32 v[76:77], v88
  v_cvt_f64_f32 v[78:79], v89
  v_cvt_f64_f32 v[80:81], v90
  v_cvt_f64_f32 v[82:83], v91
  ds_add_f64 v84, v[76:77]
  ds_add_f64 v85, v[78:79]
  ds_add_f64 v86, v[80:81]
  ds_add_f64 v87, v[82:83]
  v_lshlrev_b32 v71, 16, v65
  v_mov_b32_dpp v72, v116 quad_perm:[0,0,0,0] row_mask:0xf bank_mask:0xf
  v_mov_b32_dpp v73, v116 quad_perm:[1,1,1,1] row_mask:0xf bank_mask:0xf
  v_mov_b32_dpp v74, v116 quad_perm:[2,2,2,2] row_mask:0xf bank_mask:0xf
  v_mov_b32_dpp v75, v116 quad_perm:[3,3,3,3] row_mask:0xf bank_mask:0xf
  v_mov_b32_dpp v88, v117 quad_perm:[0,0,0,0] row_mask:0xf bank_mask:0xf
  v_mov_b32_dpp v89, v117 quad_perm:[1,1,1,1] row_mask:0xf bank_mask:0xf
  v_mov_b32_dpp v90, v117 quad_perm:[2,2,2,2] row_mask:0xf bank_mask:0xf
  v_mov_b32_dpp v91, v117 quad_perm:[3,3,3,3] row_mask:0xf bank_mask:0xf
  v_perm_b32 v88, v88, v72, v68
  v_perm_b32 v89, v89, v73, v68
  v_perm_b32 v90, v90, v74, v68
  v_perm_b32 v91, v91, v75, v68
  v_add_u32_dpp v84, v62, v5 quad_perm:[0,0,0,0] row_mask:0xf bank_mask:0xf
  v_add_u32_dpp v85, v62, v5 quad_perm:[1,1,1,1] row_mask:0xf bank_mask:0xf
  v_add_u32_dpp v86, v62, v5 quad_perm:[2,2,2,2] row_mask:0xf bank_mask:0xf
  v_add_u32_dpp v87, v62, v5 quad_perm:[3,3,3,3] row_mask:0xf bank_mask:0xf
  v_mul_f32_dpp v88, v71, v88 quad_perm:[0,0,0,0] row_mask:0xf bank_mask:0xf
  v_mul_f32_dpp v89, v71, v89 quad_perm:[1,1,1,1] row_mask:0xf bank_mask:0xf
  v_mul_f32_dpp v90, v71, v90 quad_perm:[2,2,2,2] row_mask:0xf bank_mask:0xf
  v_mul_f32_dpp v91, v71, v91 quad_perm:[3,3,3,3] row_mask:0xf bank_mask:0xf
  v_cvt_f64_f32 v[76:77], v88
  v_cvt_f64_f32 v[78:79], v89
  v_cvt_f64_f32 v[80:81], v90
  v_cvt_f64_f32 v[82:83], v91
  ds_add_f64 v84, v[76:77]
  ds_add_f64 v85, v[78:79]
  ds_add_f64 v86, v[80:81]
  ds_add_f64 v87, v[82:83]
  v_and_b32 v71, 0xffff0000, v65
  v_mov_b32_dpp v72, v118 quad_perm:[0,0,0,0] row_mask:0xf bank_mask:0xf
  v_mov_b32_dpp v73, v118 quad_perm:[1,1,1,1] row_mask:0xf bank_mask:0xf
  v_mov_b32_dpp v74, v118 quad_perm:[2,2,2,2] row_mask:0xf bank_mask:0xf
  v_mov_b32_dpp v75, v118 quad_perm:[3,3,3,3] row_mask:0xf bank_mask:0xf
  v_mov_b32_dpp v88, v119 quad_perm:[0,0,0,0] row_mask:0xf bank_mask:0xf
  v_mov_b32_dpp v89, v119 quad_perm:[1,1,1,1] row_mask:0xf bank_mask:0xf
  v_mov_b32_dpp v90, v119 quad_perm:[2,2,2,2] row_mask:0xf bank_mask:0xf
  v_mov_b32_dpp v91, v119 quad_perm:[3,3,3,3] row_mask:0xf bank_mask:0xf
  v_perm_b32 v88, v88, v72, v68
  v_perm_b32 v89, v89, v73, v68
  v_perm_b32 v90, v90, v74, v68
  v_perm_b32 v91, v91, v75, v68
  v_add_u32_dpp v84, v63, v5 quad_perm:[0,0,0,0] row_mask:0xf bank_mask:0xf
  v_add_u32_dpp v85, v63, v5 quad_perm:[1,1,1,1] row_mask:0xf bank_mask:0xf
  v_add_u32_dpp v86, v63, v5 quad_perm:[2,2,2,2] row_mask:0xf bank_mask:0xf
  v_add_u32_dpp v87, v63, v5 quad_perm:[3,3,3,3] row_mask:0xf bank_mask:0xf
  v_mul_f32_dpp v88, v71, v88 quad_perm:[0,0,0,0] row_mask:0xf bank_mask:0xf
  v_mul_f32_dpp v89, v71, v89 quad_perm:[1,1,1,1] row_mask:0xf bank_mask:0xf
  v_mul_f32_dpp v90, v71, v90 quad_perm:[2,2,2,2] row_mask:0xf bank_mask:0xf
  v_mul_f32_dpp v91, v71, v91 quad_perm:[3,3,3,3] row_mask:0xf bank_mask:0xf
  v_cvt_f64_f32 v[76:77], v88
  v_cvt_f64_f32 v[78:79], v89
  v_cvt_f64_f32 v[80:81], v90
  v_cvt_f64_f32 v[82:83], v91
  ds_add_f64 v84, v[76:77]
  ds_add_f64 v85, v[78:79]
  ds_add_f64 v86, v[80:81]
  ds_add_f64 v87, v[82:83]
L_dir_nospare:
  v_lshrrev_b32 v67, 1, v93
  buffer_load_dwordx4 v[24:27], v93, s[4:7], 0 offen
  buffer_load_dwordx2 v[38:39], v67, s[8:11], 0 offen
  v_and_b32 v70, 0x1fffff, v21
  v_ashrrev_i32 v21, 16, v21
  buffer_load_dwordx2 v[98:99], v70, s[12:15], 0 offen
  v_and_b32 v21, 0x8000ffe0, v21
  s_waitcnt vmcnt(3)
  v_lshlrev_b32 v71, 16, v36
  v_mov_b32_dpp v72, v96 quad_perm:[0,0,0,0] row_mask:0xf bank_mask:0xf
  v_mov_b32_dpp v73, v96 quad_perm:[1,1,1,1] row_mask:0xf bank_mask:0xf
  v_mov_b32_dpp v74, v96 quad_perm:[2,2,2,2] row_mask:0xf bank_mask:0xf
  v_mov_b32_dpp v75, v96 quad_perm:[3,3,3,3] row_mask:0xf bank_mask:0xf
  v_mov_b32_dpp v88, v97 quad_perm:[0,0,0,0] row_mask:0xf bank_mask:0xf
  v_mov_b32_dpp v89, v97 quad_perm:[1,1,1,1] row_mask:0xf bank_mask:0xf
  v_mov_b32_dpp v90, v97 quad_perm:[2,2,2,2] row_mask:0xf bank_mask:0xf
  v_mov_b32_dpp v91, v97 quad_perm:[3,3,3,3] row_mask:0xf bank_mask:0xf
  v_perm_b32 v88, v88, v72, v68
  v_perm_b32 v89, v89, v73, v68
  v_perm_b32 v90, v90, v74, v68
  v_perm_b32 v91, v91, v75, v68
  v_add_u32_dpp v84, v20, v5 quad_perm:[0,0,0,0] row_mask:0xf bank_mask:0xf
  v_add_u32_dpp v85, v20, v5 quad_perm:[1,1,1,1] row_mask:0xf bank_mask:0xf
  v_add_u32_dpp v86, v20, v5 quad_perm:[2,2,2,2] row_mask:0xf bank_mask:0xf
  v_add_u32_dpp v87, v20, v5 quad_perm:[3,3,3,3] row_mask:0xf bank_mask:0xf
  v_mul_f32_dpp v88, v71, v88 quad_perm:[0,0,0,0] row_mask:0xf bank_mask:0xf
  v_mul_f32_dpp v89, v71, v89 quad_perm:[1,1,1,1] row_mask:0xf bank_mask:0xf
  v_mul_f32_dpp v90, v71, v90 quad_perm:[2,2,2,2] row_mask:0xf bank_mask:0xf
  v_mul_f32_dpp v91, v71, v91 quad_perm:[3,3,3,3] row_mask:0xf bank_mask:0xf
  v_cvt_f64_f32 v[76:77], v88
  v_cvt_f64_f32 v[78:79], v89
  v_cvt_f64_f32 v[80:81], v90
  v_cvt_f64_f32 v[82:83], v91
  ds_add_f64 v84, v[76:77]
  ds_add_f64 v85, v[78:79]
  ds_add_f64 v86, v[80:81]
  ds_add_f64 v87, v[82:83]
  v_and_b32 v70, 0x1fffff, v22
  v_ashrrev_i32 v22, 16, v22
  buffer_load_dwordx2 v[100:101], v70, s[12:15], 0 offen
  v_and_b32 v22, 0x8000ffe0, v22
  s_waitcnt vmcnt(1)
  v_and_b32 v71, 0xffff0000, v36
  v_mov_b32_dpp v72, v98 quad_perm:[0,0,0,0] row_mask:0xf bank_mask:0xf
  v_mov_b32_dpp v73, v98 quad_perm:[1,1,1,1] row_mask:0xf bank_mask:0xf
  v_mov_b32_dpp v74, v98 quad_perm:[2,2,2,2] row_mask:0xf bank_mask:0xf
  v_mov_b32_dpp v75, v98 quad_perm:[3,3,3,3] row_mask:0xf bank_mask:0xf
  v_mov_b32_dpp v88, v99 quad_perm:[0,0,0,0] row_mask:0xf bank_mask:0xf
  v_mov_b32_dpp v89, v99 quad_perm:[1,1,1,1] row_mask:0xf bank_mask:0xf
  v_mov_b32_dpp v90, v99 quad_perm:[2,2,2,2] row_mask:0xf bank_mask:0xf
  v_mov_b32_dpp v91, v99 quad_perm:[3,3,3,3] row_mask:0xf bank_mask:0xf
  v_perm_b32 v88, v88, v72, v68
  v_perm_b32 v89, v89, v73, v68
  v_perm_b32 v90, v90, v74, v68
  v_perm_b32 v91, v91, v75, v68
  v_add_u32_dpp v84, v21, v5 quad_perm:[0,0,0,0] row_mask:0xf bank_mask:0xf
  v_add_u32_dpp v85, v21, v5 quad_perm:[1,1,1,1] row_mask:0xf bank_mask:0xf
  v_add_u32_dpp v86, v21, v5 quad_perm:[2,2,2,2] row_mask:0xf bank_mask:0xf
  v_add_u32_dpp v87, v21, v5 quad_perm:[3,3,3,3] row_mask:0xf bank_mask:0xf
  v_mul_f32_dpp v88, v71, v88 quad_perm:[0,0,0,0] row_mask:0xf bank_mask:0xf
  v_mul_f32_dpp v89, v71, v89 quad_perm:[1,1,1,1] row_mask:0xf bank_mask:0xf
  v_mul_f32_dpp v90, v71, v90 quad_perm:[2,2,2,2] row_mask:0xf bank_mask:0xf
  v_mul_f32_dpp v91, v71, v91 quad_perm:[3,3,3,3] row_mask:0xf bank_mask:0xf
  v_cvt_f64_f32 v[76:77], v88
  v_cvt_f64_f32 v[78:79], v89
  v_cvt_f64_f32 v[80:81], v90
  v_cvt_f64_f32 v[82:83], v91
  ds_add_f64 v84, v[76:77]
  ds_add_f64 v85, v[78:79]
  ds_add_f64 v86, v[80:81]
  ds_add_f64 v87, v[82:83]
  v_and_b32 v70, 0x1fffff, v23
  v_ashrrev_i32 v23, 16, v23
  buffer_load_dwordx2 v[96:97], v70, s[12:15], 0 offen
  v_and_b32 v23, 0x8000ffe0, v23
  s_waitcnt vmcnt(1)
  v_lshlrev_b32 v71, 16, v37
  v_mov_b32_dpp v72, v100 quad_perm:[0,0,0,0] row_mask:0xf bank_mask:0xf
  v_mov_b32_dpp v73, v100 quad_perm:[1,1,1,1] row_mask:0xf bank_mask:0xf
  v_mov_b32_dpp v74, v100 quad_perm:[2,2,2,2] row_mask:0xf bank_mask:0xf
  v_mov_b32_dpp v75, v100 quad_perm:[3,3,3,3] row_mask:0xf bank_mask:0xf
  v_mov_b32_dpp v88, v101 quad_perm:[0,0,0,0] row_mask:0xf bank_mask:0xf
  v_mov_b32_dpp v89, v101 quad_perm:[1,1,1,1] row_mask:0xf bank_mask:0xf
  v_mov_b32_dpp v90, v101 quad_perm:[2,2,2,2] row_mask:0xf bank_mask:0xf
  v_mov_b32_dpp v91, v101 quad_perm:[3,3,3,3] row_mask:0xf bank_mask:0xf
  v_perm_b32 v88, v88, v72, v68
  v_perm_b32 v89, v89, v73, v68
  v_perm_b32 v90, v90, v74, v68
  v_perm_b32 v91, v91, v75, v68
  v_add_u32_dpp v84, v22, v5 quad_perm:[0,0,0,0] row_mask:0xf bank_mask:0xf
  v_add_u32_dpp v85, v22, v5 quad_perm:[1,1,1,1] row_mask:0xf bank_mask:0xf
  v_add_u32_dpp v86, v22, v5 quad_perm:[2,2,2,2] row_mask:0xf bank_mask:0xf
  v_add_u32_dpp v87, v22, v5 quad_perm:[3,3,3,3] row_mask:0xf bank_mask:0xf
  v_mul_f32_dpp v88, v71, v88 quad_perm:[0,0,0,0] row_mask:0xf bank_mask:0xf
  v_mul_f32_dpp v89, v71, v89 quad_perm:[1,1,1,1] row_mask:0xf bank_mask:0xf
  v_mul_f32_dpp v90, v71, v90 quad_perm:[2,2,2,2] row_mask:0xf bank_mask:0xf
  v_mul_f32_dpp v91, v71, v91 quad_perm:[3,3,3,3] row_mask:0xf bank_mask:0xf
  v_cvt_f64_f32 v[76:77], v88
  v_cvt_f64_f32 v[78:79], v89
  v_cvt_f64_f32 v[80:81], v90
  v_cvt_f64_f32 v[82:83], v91
  ds_add_f64 v84, v[76:77]
  ds_add_f64 v85, v[78:79]
  ds_add_f64 v86, v[80:81]
  ds_add_f64 v87, v[82:83]
  s_waitcnt vmcnt(4)
  v_cmp_lt_i32 s[88:89], 0, v53
  v_cmp_lt_i32 s[90:91], 1, v53
  v_cmp_lt_i32 s[92:93], 2, v53
  v_cmp_lt_i32 s[94:95], 3, v53
  v_cndmask_b32 v24, -1, v24, s[88:89]
  v_cndmask_b32 v25, -1, v25, s[90:91]
  v_cndmask_b32 v26, -1, v26, s[92:93]
  v_cndmask_b32 v27, -1, v27, s[94:95]
  v_and_b32 v70, 0x1fffff, v24
  v_ashrrev_i32 v24, 16, v24
  buffer_load_dwordx2 v[98:99], v70, s[12:15], 0 offen
  v_and_b32 v24, 0x8000ffe0, v24
  s_waitcnt vmcnt(1)
  v_and_b32 v71, 0xffff0000, v37
  v_mov_b32_dpp v72, v96 quad_perm:[0,0,0,0] row_mask:0xf bank_mask:0xf
  v_mov_b32_dpp v73, v96 quad_perm:[1,1,1,1] row_mask:0xf bank_mask:0xf
  v_mov_b32_dpp v74, v96 quad_perm:[2,2,2,2] row_mask:0xf bank_mask:0xf
  v_mov_b32_dpp v75, v96 quad_perm:[3,3,3,3] row_mask:0xf bank_mask:0xf
  v_mov_b32_dpp v88, v97 quad_perm:[0,0,0,0] row_mask:0xf bank_mask:0xf
  v_mov_b32_dpp v89, v97 quad_perm:[1,1,1,1] row_mask:0xf bank_mask:0xf
  v_mov_b32_dpp v90, v97 quad_perm:[2,2,2,2] row_mask:0xf bank_mask:0xf
  v_mov_b32_dpp v91, v97 quad_perm:[3,3,3,3] row_mask:0xf bank_mask:0xf
  v_perm_b32 v88, v88, v72, v68
  v_perm_b32 v89, v89, v73, v68
  v_perm_b32 v90, v90, v74, v68
  v_perm_b32 v91, v91, v75, v68
  v_add_u32_dpp v84, v23, v5 quad_perm:[0,0,0,0] row_mask:0xf bank_mask:0xf
  v_add_u32_dpp v85, v23, v5 quad_perm:[1,1,1,1] row_mask:0xf bank_mask:0xf
  v_add_u32_dpp v86, v23, v5 quad_perm:[2,2,2,2] row_mask:0xf bank_mask:0xf
  v_add_u32_dpp v87, v23, v5 quad_perm:[3,3,3,3] row_mask:0xf bank_mask:0xf
  v_mul_f32_dpp v88, v71, v88 quad_perm:[0,0,0,0] row_mask:0xf bank_mask:0xf
  v_mul_f32_dpp v89, v71, v89 quad_perm:[1,1,1,1] row_mask:0xf bank_mask:0xf
  v_mul_f32_dpp v90, v71, v90 quad_perm:[2,2,2,2] row_mask:0xf bank_mask:0xf
  v_mul_f32_dpp v91, v71, v91 quad_perm:[3,3,3,3] row_mask:0xf bank_mask:0xf
  v_cvt_f64_f32 v[76:77], v88
  v_cvt_f64_f32 v[78:79], v89
  v_cvt_f64_f32 v[80:81], v90
  v_cvt_f64_f32 v[82:83], v91
  ds_add_f64 v84, v[76:77]
  ds_add_f64 v85, v[78:79]
  ds_add_f64 v86, v[80:81]
  ds_add_f64 v87, v[82:83]
  v_lshrrev_b32 v67, 1, v94
  buffer_load_dwordx4 v[28:31], v94, s[4:7], 0 offen
  buffer_load_dwordx2 v[40:41], v67, s[8:11], 0 offen
  v_and_b32 v70, 0x1fffff, v25
  v_ashrrev_i32 v25, 16, v25
  buffer_load_dwordx2 v[100:101], v70, s[12:15], 0 offen
  v_and_b32 v25, 0x8000ffe0, v25
  s_waitcnt vmcnt(3)
  v_lshlrev_b32 v71, 16, v38
  v_mov_b32_dpp v72, v98 quad_perm:[0,0,0,0] row_mask:0xf bank_mask:0xf
  v_mov_b32_dpp v73, v98 quad_perm:[1,1,1,1] row_mask:0xf bank_mask:0xf
  v_mov_b32_dpp v74, v98 quad_perm:[2,2,2,2] row_mask:0xf bank_mask:0xf
  v_mov_b32_dpp v75, v98 quad_perm:[3,3,3,3] row_mask:0xf bank_mask:0xf
  v_mov_b32_dpp v88, v99 quad_perm:[0,0,0,0] row_mask:0xf bank_mask:0xf
  v_mov_b32_dpp v89, v99 quad_perm:[1,1,1,1] row_mask:0xf bank_mask:0xf
  v_mov_b32_dpp v90, v99 quad_perm:[2,2,2,2] row_mask:0xf bank_mask:0xf
  v_mov_b32_dpp v91, v99 quad_perm:[3,3,3,3] row_mask:0xf bank_mask:0xf
  v_perm_b32 v88, v88, v72, v68
  v_perm_b32 v89, v89, v73, v68
  v_perm_b32 v90, v90, v74, v68
  v_perm_b32 v91, v91, v75, v68
  v_add_u32_dpp v84, v24, v5 quad_perm:[0,0,0,0] row_mask:0xf bank_mask:0xf
  v_add_u32_dpp v85, v24, v5 quad_perm:[1,1,1,1] row_mask:0xf bank_mask:0xf
  v_add_u32_dpp v86, v24, v5 quad_perm:[2,2,2,2] row_mask:0xf bank_mask:0xf
  v_add_u32_dpp v87, v24, v5 quad_perm:[3,3,3,3] row_mask:0xf bank_mask:0xf
  v_mul_f32_dpp v88, v71, v88 quad_perm:[0,0,0,0] row_mask:0xf bank_mask:0xf
  v_mul_f32_dpp v89, v71, v89 quad_perm:[1,1,1,1] row_mask:0xf bank_mask:0xf
  v_mul_f32_dpp v90, v71, v90 quad_perm:[2,2,2,2] row_mask:0xf bank_mask:0xf
  v_mul_f32_dpp v91, v71, v91 quad_perm:[3,3,3,3] row_mask:0xf bank_mask:0xf
  v_cvt_f64_f32 v[76:77], v88
  v_cvt_f64_f32 v[78:79], v89
  v_cvt_f64_f32 v[80:81], v90
  v_cvt_f64_f32 v[82:83], v91
  ds_add_f64 v84, v[76:77]
  ds_add_f64 v85, v[78:79]
  ds_add_f64 v86, v[80:81]
  ds_add_f64 v87, v[82:83]
  v_and_b32 v70, 0x1fffff, v26
  v_ashrrev_i32 v26, 16, v26
  buffer_load_dwordx2 v[96:97], v70, s[12:15], 0 offen
  v_and_b32 v26, 0x8000ffe0, v26
  s_waitcnt vmcnt(1)
  v_and_b32 v71, 0xffff0000, v38
  v_mov_b32_dpp v72, v100 quad_perm:[0,0,0,0] row_mask:0xf bank_mask:0xf
  v_mov_b32_dpp v73, v100 quad_perm:[1,1,1,1] row_mask:0xf bank_mask:0xf
  v_mov_b32_dpp v74, v100 quad_perm:[2,2,2,2] row_mask:0xf bank_mask:0xf
  v_mov_b32_dpp v75, v100 quad_perm:[3,3,3,3] row_mask:0xf bank_mask:0xf
  v_mov_b32_dpp v88, v101 quad_perm:[0,0,0,0] row_mask:0xf bank_mask:0xf
  v_mov_b32_dpp v89, v101 quad_perm:[1,1,1,1] row_mask:0xf bank_mask:0xf
  v_mov_b32_dpp v90, v101 quad_perm:[2,2,2,2] row_mask:0xf bank_mask:0xf
  v_mov_b32_dpp v91, v101 quad_perm:[3,3,3,3] row_mask:0xf bank_mask:0xf
  v_perm_b32 v88, v88, v72, v68
  v_perm_b32 v89, v89, v73, v68
  v_perm_b32 v90, v90, v74, v68
  v_perm_b32 v91, v91, v75, v68
  v_add_u32_dpp v84, v25, v5 quad_perm:[0,0,0,0] row_mask:0xf bank_mask:0xf
  v_add_u32_dpp v85, v25, v5 quad_perm:[1,1,1,1] row_mask:0xf bank_mask:0xf
  v_add_u32_dpp v86, v25, v5 quad_perm:[2,2,2,2] row_mask:0xf bank_mask:0xf
  v_add_u32_dpp v87, v25, v5 quad_perm:[3,3,3,3] row_mask:0xf bank_mask:0xf
  v_mul_f32_dpp v88, v71, v88 quad_perm:[0,0,0,0] row_mask:0xf bank_mask:0xf
  v_mul_f32_dpp v89, v71, v89 quad_perm:[1,1,1,1] row_mask:0xf bank_mask:0xf
  v_mul_f32_dpp v90, v71, v90 quad_perm:[2,2,2,2] row_mask:0xf bank_mask:0xf
  v_mul_f32_dpp v91, v71, v91 quad_perm:[3,3,3,3] row_mask:0xf bank_mask:0xf
  v_cvt_f64_f32 v[76:77], v88
  v_cvt_f64_f32 v[78:79], v89
  v_cvt_f64_f32 v[80:81], v90
  v_cvt_f64_f32 v[82:83], v91
  ds_add_f64 v84, v[76:77]
  ds_add_f64 v85, v[78:79]
  ds_add_f64 v86, v[80:81]
  ds_add_f64 v87, v[82:83]
  v_and_b32 v70, 0x1fffff, v27
  v_ashrrev_i32 v27, 16, v27
  buffer_load_dwordx2 v[98:99], v70, s[12:15], 0 offen
  v_and_b32 v27, 0x8000ffe0, v27
  s_waitcnt vmcnt(1)
  v_lshlrev_b32 v71, 16, v39
  v_mov_b32_dpp v72, v96 quad_perm:[0,0,0,0] row_mask:0xf bank_mask:0xf
  v_mov_b32_dpp v73, v96 quad_perm:[1,1,1,1] row_mask:0xf bank_mask:0xf
  v_mov_b32_dpp v74, v96 quad_perm:[2,2,2,2] row_mask:0xf bank_mask:0xf
  v_mov_b32_dpp v75, v96 quad_perm:[3,3,3,3] row_mask:0xf bank_mask:0xf
  v_mov_b32_dpp v88, v97 quad_perm:[0,0,0,0] row_mask:0xf bank_mask:0xf
  v_mov_b32_dpp v89, v97 quad_perm:[1,1,1,1] row_mask:0xf bank_mask:0xf
  v_mov_b32_dpp v90, v97 quad_perm:[2,2,2,2] row_mask:0xf bank_mask:0xf
  v_mov_b32_dpp v91, v97 quad_perm:[3,3,3,3] row_mask:0xf bank_mask:0xf
  v_perm_b32 v88, v88, v72, v68
  v_perm_b32 v89, v89, v73, v68
  v_perm_b32 v90, v90, v74, v68
  v_perm_b32 v91, v91, v75, v68
  v_add_u32_dpp v84, v26, v5 quad_perm:[0,0,0,0] row_mask:0xf bank_mask:0xf
  v_add_u32_dpp v85, v26, v5 quad_perm:[1,1,1,1] row_mask:0xf bank_mask:0xf
  v_add_u32_dpp v86, v26, v5 quad_perm:[2,2,2,2] row_mask:0xf bank_mask:0xf
  v_add_u32_dpp v87, v26, v5 quad_perm:[3,3,3,3] row_mask:0xf bank_mask:0xf
  v_mul_f32_dpp v88, v71, v88 quad_perm:[0,0,0,0] row_mask:0xf bank_mask:0xf
  v_mul_f32_dpp v89, v71, v89 quad_perm:[1,1,1,1] row_mask:0xf bank_mask:0xf
  v_mul_f32_dpp v90, v71, v90 quad_perm:[2,2,2,2] row_mask:0xf bank_mask:0xf
  v_mul_f32_dpp v91, v71, v91 quad_perm:[3,3,3,3] row_mask:0xf bank_mask:0xf
  v_cvt_f64_f32 v[76:77], v88
  v_cvt_f64_f32 v[78:79], v89
  v_cvt_f64_f32 v[80:81], v90
  v_cvt_f64_f32 v[82:83], v91
  ds_add_f64 v84, v[76:77]
  ds_add_f64 v85, v[78:79]
  ds_add_f64 v86, v[80:81]
  ds_add_f64 v87, v[82:83]
  s_waitcnt vmcnt(4)
  v_cmp_lt_i32 s[88:89], 0, v54
  v_cmp_lt_i32 s[90:91], 1, v54
  v_cmp_lt_i32 s[92:93], 2, v54
  v_cmp_lt_i32 s[94:95], 3, v54
  v_cndmask_b32 v28, -1, v28, s[88:89]
  v_cndmask_b32 v29, -1, v29, s[90:91]
  v_cndmask_b32 v30, -1, v30, s[92:93]
  v_cndmask_b32 v31, -1, v31, s[94:95]
  v_and_b32 v70, 0x1fffff, v28
  v_ashrrev_i32 v28, 16, v28
  buffer_load_dwordx2 v[100:101], v70, s[12:15], 0 offen
  v_and_b32 v28, 0x8000ffe0, v28
  s_waitcnt vmcnt(1)
  v_and_b32 v71, 0xffff0000, v39
  v_mov_b32_dpp v72, v98 quad_perm:[0,0,0,0] row_mask:0xf bank_mask:0xf
  v_mov_b32_dpp v73, v98 quad_perm:[1,1,1,1] row_mask:0xf bank_mask:0xf
  v_mov_b32_dpp v74, v98 quad_perm:[2,2,2,2] row_mask:0xf bank_mask:0xf
  v_mov_b32_dpp v75, v98 quad_perm:[3,3,3,3] row_mask:0xf bank_mask:0xf
  v_mov_b32_dpp v88, v99 quad_perm:[0,0,0,0] row_mask:0xf bank_mask:0xf
  v_mov_b32_dpp v89, v99 quad_perm:[1,1,1,1] row_mask:0xf bank_mask:0xf
  v_mov_b32_dpp v90, v99 quad_perm:[2,2,2,2] row_mask:0xf bank_mask:0xf
  v_mov_b32_dpp v91, v99 quad_perm:[3,3,3,3] row_mask:0xf bank_mask:0xf
  v_perm_b32 v88, v88, v72, v68
  v_perm_b32 v89, v89, v73, v68
  v_perm_b32 v90, v90, v74, v68
  v_perm_b32 v91, v91, v75, v68
  v_add_u32_dpp v84, v27, v5 quad_perm:[0,0,0,0] row_mask:0xf bank_mask:0xf
  v_add_u32_dpp v85, v27, v5 quad_perm:[1,1,1,1] row_mask:0xf bank_mask:0xf
  v_add_u32_dpp v86, v27, v5 quad_perm:[2,2,2,2] row_mask:0xf bank_mask:0xf
  v_add_u32_dpp v87, v27, v5 quad_perm:[3,3,3,3] row_mask:0xf bank_mask:0xf
  v_mul_f32_dpp v88, v71, v88 quad_perm:[0,0,0,0] row_mask:0xf bank_mask:0xf
  v_mul_f32_dpp v89, v71, v89 quad_perm:[1,1,1,1] row_mask:0xf bank_mask:0xf
  v_mul_f32_dpp v90, v71, v90 quad_perm:[2,2,2,2] row_mask:0xf bank_mask:0xf
  v_mul_f32_dpp v91, v71, v91 quad_perm:[3,3,3,3] row_mask:0xf bank_mask:0xf
  v_cvt_f64_f32 v[76:77], v88
  v_cvt_f64_f32 v[78:79], v89
  v_cvt_f64_f32 v[80:81], v90
  v_cvt_f64_f32 v[82:83], v91
  ds_add_f64 v84, v[76:77]
  ds_add_f64 v85, v[78:79]
  ds_add_f64 v86, v[80:81]
  ds_add_f64 v87, v[82:83]
  v_lshrrev_b32 v67, 1, v66
  buffer_load_dwordx4 v[32:35], v66, s[4:7], 0 offen
  buffer_load_dwordx2 v[42:43], v67, s[8:11], 0 offen
  v_and_b32 v70, 0x1fffff, v29
  v_ashrrev_i32 v29, 16, v29
  buffer_load_dwordx2 v[96:97], v70, s[12:15], 0 offen
  v_and_b32 v29, 0x8000ffe0, v29
  s_waitcnt vmcnt(3)
  v_lshlrev_b32 v71, 16, v40
  v_mov_b32_dpp v72, v100 quad_perm:[0,0,0,0] row_mask:0xf bank_mask:0xf
  v_mov_b32_dpp v73, v100 quad_perm:[1,1,1,1] row_mask:0xf bank_mask:0xf
  v_mov_b32_dpp v74, v100 quad_perm:[2,2,2,2] row_mask:0xf bank_mask:0xf
  v_mov_b32_dpp v75, v100 quad_perm:[3,3,3,3] row_mask:0xf bank_mask:0xf
  v_mov_b32_dpp v88, v101 quad_perm:[0,0,0,0] row_mask:0xf bank_mask:0xf
  v_mov_b32_dpp v89, v101 quad_perm:[1,1,1,1] row_mask:0xf bank_mask:0xf
  v_mov_b32_dpp v90, v101 quad_perm:[2,2,2,2] row_mask:0xf bank_mask:0xf
  v_mov_b32_dpp v91, v101 quad_perm:[3,3,3,3] row_mask:0xf bank_mask:0xf
  v_perm_b32 v88, v88, v72, v68
  v_perm_b32 v89, v89, v73, v68
  v_perm_b32 v90, v90, v74, v68
  v_perm_b32 v91, v91, v75, v68
  v_add_u32_dpp v84, v28, v5 quad_perm:[0,0,0,0] row_mask:0xf bank_mask:0xf
  v_add_u32_dpp v85, v28, v5 quad_perm:[1,1,1,1] row_mask:0xf bank_mask:0xf
  v_add_u32_dpp v86, v28, v5 quad_perm:[2,2,2,2] row_mask:0xf bank_mask:0xf
  v_add_u32_dpp v87, v28, v5 quad_perm:[3,3,3,3] row_mask:0xf bank_mask:0xf
  v_mul_f32_dpp v88, v71, v88 quad_perm:[0,0,0,0] row_mask:0xf bank_mask:0xf
  v_mul_f32_dpp v89, v71, v89 quad_perm:[1,1,1,1] row_mask:0xf bank_mask:0xf
  v_mul_f32_dpp v90, v71, v90 quad_perm:[2,2,2,2] row_mask:0xf bank_mask:0xf
  v_mul_f32_dpp v91, v71, v91 quad_perm:[3,3,3,3] row_mask:0xf bank_mask:0xf
  v_cvt_f64_f32 v[76:77], v88
  v_cvt_f64_f32 v[78:79], v89
  v_cvt_f64_f32 v[80:81], v90
  v_cvt_f64_f32 v[82:83], v91
  ds_add_f64 v84, v[76:77]
  ds_add_f64 v85, v[78:79]
  ds_add_f64 v86, v[80:81]
  ds_add_f64 v87, v[82:83]
  v_and_b32 v70, 0x1fffff, v30
  v_ashrrev_i32 v30, 16, v30
  buffer_load_dwordx2 v[98:99], v70, s[12:15], 0 offen
  v_and_b32 v30, 0x8000ffe0, v30
  s_waitcnt vmcnt(1)
  v_and_b32 v71, 0xffff0000, v40
  v_mov_b32_dpp v72, v96 quad_perm:[0,0,0,0] row_mask:0xf bank_mask:0xf
  v_mov_b32_dpp v73, v96 quad_perm:[1,1,1,1] row_mask:0xf bank_mask:0xf
  v_mov_b32_dpp v74, v96 quad_perm:[2,2,2,2] row_mask:0xf bank_mask:0xf
  v_mov_b32_dpp v75, v96 quad_perm:[3,3,3,3] row_mask:0xf bank_mask:0xf
  v_mov_b32_dpp v88, v97 quad_perm:[0,0,0,0] row_mask:0xf bank_mask:0xf
  v_mov_b32_dpp v89, v97 quad_perm:[1,1,1,1] row_mask:0xf bank_mask:0xf
  v_mov_b32_dpp v90, v97 quad_perm:[2,2,2,2] row_mask:0xf bank_mask:0xf
  v_mov_b32_dpp v91, v97 quad_perm:[3,3,3,3] row_mask:0xf bank_mask:0xf
  v_perm_b32 v88, v88, v72, v68
  v_perm_b32 v89, v89, v73, v68
  v_perm_b32 v90, v90, v74, v68
  v_perm_b32 v91, v91, v75, v68
  v_add_u32_dpp v84, v29, v5 quad_perm:[0,0,0,0] row_mask:0xf bank_mask:0xf
  v_add_u32_dpp v85, v29, v5 quad_perm:[1,1,1,1] row_mask:0xf bank_mask:0xf
  v_add_u32_dpp v86, v29, v5 quad_perm:[2,2,2,2] row_mask:0xf bank_mask:0xf
  v_add_u32_dpp v87, v29, v5 quad_perm:[3,3,3,3] row_mask:0xf bank_mask:0xf
  v_mul_f32_dpp v88, v71, v88 quad_perm:[0,0,0,0] row_mask:0xf bank_mask:0xf
  v_mul_f32_dpp v89, v71, v89 quad_perm:[1,1,1,1] row_mask:0xf bank_mask:0xf
  v_mul_f32_dpp v90, v71, v90 quad_perm:[2,2,2,2] row_mask:0xf bank_mask:0xf
  v_mul_f32_dpp v91, v71, v91 quad_perm:[3,3,3,3] row_mask:0xf bank_mask:0xf
  v_cvt_f64_f32 v[76:77], v88
  v_cvt_f64_f32 v[78:79], v89
  v_cvt_f64_f32 v[80:81], v90
  v_cvt_f64_f32 v[82:83], v91
  ds_add_f64 v84, v[76:77]
  ds_add_f64 v85, v[78:79]
  ds_add_f64 v86, v[80:81]
  ds_add_f64 v87, v[82:83]
  v_and_b32 v70, 0x1fffff, v31
  v_ashrrev_i32 v31, 16, v31
  buffer_load_dwordx2 v[100:101], v70, s[12:15], 0 offen
  v_and_b32 v31, 0x8000ffe0, v31
  s_waitcnt vmcnt(1)
  v_lshlrev_b32 v71, 16, v41
  v_mov_b32_dpp v72, v98 quad_perm:[0,0,0,0] row_mask:0xf bank_mask:0xf
  v_mov_b32_dpp v73, v98 quad_perm:[1,1,1,1] row_mask:0xf bank_mask:0xf
  v_mov_b32_dpp v74, v98 quad_perm:[2,2,2,2] row_mask:0xf bank_mask:0xf
  v_mov_b32_dpp v75, v98 quad_perm:[3,3,3,3] row_mask:0xf bank_mask:0xf
  v_mov_b32_dpp v88, v99 quad_perm:[0,0,0,0] row_mask:0xf bank_mask:0xf
  v_mov_b32_dpp v89, v99 quad_perm:[1,1,1,1] row_mask:0xf bank_mask:0xf
  v_mov_b32_dpp v90, v99 quad_perm:[2,2,2,2] row_mask:0xf bank_mask:0xf
  v_mov_b32_dpp v91, v99 quad_perm:[3,3,3,3] row_mask:0xf bank_mask:0xf
  v_perm_b32 v88, v88, v72, v68
  v_perm_b32 v89, v89, v73, v68
  v_perm_b32 v90, v90, v74, v68
  v_perm_b32 v91, v91, v75, v68
  v_add_u32_dpp v84, v30, v5 quad_perm:[0,0,0,0] row_mask:0xf bank_mask:0xf
  v_add_u32_dpp v85, v30, v5 quad_perm:[1,1,1,1] row_mask:0xf bank_mask:0xf
  v_add_u32_dpp v86, v30, v5 quad_perm:[2,2,2,2] row_mask:0xf bank_mask:0xf
  v_add_u32_dpp v87, v30, v5 quad_perm:[3,3,3,3] row_mask:0xf bank_mask:0xf
  v_mul_f32_dpp v88, v71, v88 quad_perm:[0,0,0,0] row_mask:0xf bank_mask:0xf
  v_mul_f32_dpp v89, v71, v89 quad_perm:[1,1,1,1] row_mask:0xf bank_mask:0xf
  v_mul_f32_dpp v90, v71, v90 quad_perm:[2,2,2,2] row_mask:0xf bank_mask:0xf
  v_mul_f32_dpp v91, v71, v91 quad_perm:[3,3,3,3] row_mask:0xf bank_mask:0xf
  v_cvt_f64_f32 v[76:77], v88
  v_cvt_f64_f32 v[78:79], v89
  v_cvt_f64_f32 v[80:81], v90
  v_cvt_f64_f32 v[82:83], v91
  ds_add_f64 v84, v[76:77]
  ds_add_f64 v85, v[78:79]
  ds_add_f64 v86, v[80:81]
  ds_add_f64 v87, v[82:83]
  s_waitcnt vmcnt(4)
  v_cmp_lt_i32 s[88:89], 0, v55
  v_cmp_lt_i32 s[90:91], 1, v55
  v_cmp_lt_i32 s[92:93], 2, v55
  v_cmp_lt_i32 s[94:95], 3, v55
  v_cndmask_b32 v32, -1, v32, s[88:89]
  v_cndmask_b32 v33, -1, v33, s[90:91]
  v_cndmask_b32 v34, -1, v34, s[92:93]
  v_cndmask_b32 v35, -1, v35, s[94:95]
  v_and_b32 v70, 0x1fffff, v32
  v_ashrrev_i32 v32, 16, v32
  buffer_load_dwordx2 v[96:97], v70, s[12:15], 0 offen
  v_and_b32 v32, 0x8000ffe0, v32
  s_waitcnt vmcnt(1)
  v_and_b32 v71, 0xffff0000, v41
  v_mov_b32_dpp v72, v100 quad_perm:[0,0,0,0] row_mask:0xf bank_mask:0xf
  v_mov_b32_dpp v73, v100 quad_perm:[1,1,1,1] row_mask:0xf bank_mask:0xf
  v_mov_b32_dpp v74, v100 quad_perm:[2,2,2,2] row_mask:0xf bank_mask:0xf
  v_mov_b32_dpp v75, v100 quad_perm:[3,3,3,3] row_mask:0xf bank_mask:0xf
  v_mov_b32_dpp v88, v101 quad_perm:[0,0,0,0] row_mask:0xf bank_mask:0xf
  v_mov_b32_dpp v89, v101 quad_perm:[1,1,1,1] row_mask:0xf bank_mask:0xf
  v_mov_b32_dpp v90, v101 quad_perm:[2,2,2,2] row_mask:0xf bank_mask:0xf
  v_mov_b32_dpp v91, v101 quad_perm:[3,3,3,3] row_mask:0xf bank_mask:0xf
  v_perm_b32 v88, v88, v72, v68
  v_perm_b32 v89, v89, v73, v68
  v_perm_b32 v90, v90, v74, v68
  v_perm_b32 v91, v91, v75, v68
  v_add_u32_dpp v84, v31, v5 quad_perm:[0,0,0,0] row_mask:0xf bank_mask:0xf
  v_add_u32_dpp v85, v31, v5 quad_perm:[1,1,1,1] row_mask:0xf bank_mask:0xf
  v_add_u32_dpp v86, v31, v5 quad_perm:[2,2,2,2] row_mask:0xf bank_mask:0xf
  v_add_u32_dpp v87, v31, v5 quad_perm:[3,3,3,3] row_mask:0xf bank_mask:0xf
  v_mul_f32_dpp v88, v71, v88 quad_perm:[0,0,0,0] row_mask:0xf bank_mask:0xf
  v_mul_f32_dpp v89, v71, v89 quad_perm:[1,1,1,1] row_mask:0xf bank_mask:0xf
  v_mul_f32_dpp v90, v71, v90 quad_perm:[2,2,2,2] row_mask:0xf bank_mask:0xf
  v_mul_f32_dpp v91, v71, v91 quad_perm:[3,3,3,3] row_mask:0xf bank_mask:0xf
  v_cvt_f64_f32 v[76:77], v88
  v_cvt_f64_f32 v[78:79], v89
  v_cvt_f64_f32 v[80:81], v90
  v_cvt_f64_f32 v[82:83], v91
  ds_add_f64 v84, v[76:77]
  ds_add_f64 v85, v[78:79]
  ds_add_f64 v86, v[80:81]
  ds_add_f64 v87, v[82:83]
  v_and_b32 v70, 0x1fffff, v33
  v_ashrrev_i32 v33, 16, v33
  buffer_load_dwordx2 v[98:99], v70, s[12:15], 0 offen
  v_and_b32 v33, 0x8000ffe0, v33
  s_waitcnt vmcnt(1)
  v_lshlrev_b32 v71, 16, v42
  v_mov_b32_dpp v72, v96 quad_perm:[0,0,0,0] row_mask:0xf bank_mask:0xf
  v_mov_b32_dpp v73, v96 quad_perm:[1,1,1,1] row_mask:0xf bank_mask:0xf
  v_mov_b32_dpp v74, v96 quad_perm:[2,2,2,2] row_mask:0xf bank_mask:0xf
  v_mov_b32_dpp v75, v96 quad_perm:[3,3,3,3] row_mask:0xf bank_mask:0xf
  v_mov_b32_dpp v88, v97 quad_perm:[0,0,0,0] row_mask:0xf bank_mask:0xf
  v_mov_b32_dpp v89, v97 quad_perm:[1,1,1,1] row_mask:0xf bank_mask:0xf
  v_mov_b32_dpp v90, v97 quad_perm:[2,2,2,2] row_mask:0xf bank_mask:0xf
  v_mov_b32_dpp v91, v97 quad_perm:[3,3,3,3] row_mask:0xf bank_mask:0xf
  v_perm_b32 v88, v88, v72, v68
  v_perm_b32 v89, v89, v73, v68
  v_perm_b32 v90, v90, v74, v68
  v_perm_b32 v91, v91, v75, v68
  v_add_u32_dpp v84, v32, v5 quad_perm:[0,0,0,0] row_mask:0xf bank_mask:0xf
  v_add_u32_dpp v85, v32, v5 quad_perm:[1,1,1,1] row_mask:0xf bank_mask:0xf
  v_add_u32_dpp v86, v32, v5 quad_perm:[2,2,2,2] row_mask:0xf bank_mask:0xf
  v_add_u32_dpp v87, v32, v5 quad_perm:[3,3,3,3] row_mask:0xf bank_mask:0xf
  v_mul_f32_dpp v88, v71, v88 quad_perm:[0,0,0,0] row_mask:0xf bank_mask:0xf
  v_mul_f32_dpp v89, v71, v89 quad_perm:[1,1,1,1] row_mask:0xf bank_mask:0xf
  v_mul_f32_dpp v90, v71, v90 quad_perm:[2,2,2,2] row_mask:0xf bank_mask:0xf
  v_mul_f32_dpp v91, v71, v91 quad_perm:[3,3,3,3] row_mask:0xf bank_mask:0xf
  v_cvt_f64_f32 v[76:77], v88
  v_cvt_f64_f32 v[78:79], v89
  v_cvt_f64_f32 v[80:81], v90
  v_cvt_f64_f32 v[82:83], v91
  ds_add_f64 v84, v[76:77]
  ds_add_f64 v85, v[78:79]
  ds_add_f64 v86, v[80:81]
  ds_add_f64 v87, v[82:83]
  v_and_b32 v70, 0x1fffff, v34
  v_ashrrev_i32 v34, 16, v34
  buffer_load_dwordx2 v[100:101], v70, s[12:15], 0 offen
  v_and_b32 v34, 0x8000ffe0, v34
  s_waitcnt vmcnt(1)
  v_and_b32 v71, 0xffff0000, v42
  v_mov_b32_dpp v72, v98 quad_perm:[0,0,0,0] row_mask:0xf bank_mask:0xf
  v_mov_b32_dpp v73, v98 quad_perm:[1,1,1,1] row_mask:0xf bank_mask:0xf
  v_mov_b32_dpp v74, v98 quad_perm:[2,2,2,2] row_mask:0xf bank_mask:0xf
  v_mov_b32_dpp v75, v98 quad_perm:[3,3,3,3] row_mask:0xf bank_mask:0xf
  v_mov_b32_dpp v88, v99 quad_perm:[0,0,0,0] row_mask:0xf bank_mask:0xf
  v_mov_b32_dpp v89, v99 quad_perm:[1,1,1,1] row_mask:0xf bank_mask:0xf
  v_mov_b32_dpp v90, v99 quad_perm:[2,2,2,2] row_mask:0xf bank_mask:0xf
  v_mov_b32_dpp v91, v99 quad_perm:[3,3,3,3] row_mask:0xf bank_mask:0xf
  v_perm_b32 v88, v88, v72, v68
  v_perm_b32 v89, v89, v73, v68
  v_perm_b32 v90, v90, v74, v68
  v_perm_b32 v91, v91, v75, v68
  v_add_u32_dpp v84, v33, v5 quad_perm:[0,0,0,0] row_mask:0xf bank_mask:0xf
  v_add_u32_dpp v85, v33, v5 quad_perm:[1,1,1,1] row_mask:0xf bank_mask:0xf
  v_add_u32_dpp v86, v33, v5 quad_perm:[2,2,2,2] row_mask:0xf bank_mask:0xf
  v_add_u32_dpp v87, v33, v5 quad_perm:[3,3,3,3] row_mask:0xf bank_mask:0xf
  v_mul_f32_dpp v88, v71, v88 quad_perm:[0,0,0,0] row_mask:0xf bank_mask:0xf
  v_mul_f32_dpp v89, v71, v89 quad_perm:[1,1,1,1] row_mask:0xf bank_mask:0xf
  v_mul_f32_dpp v90, v71, v90 quad_perm:[2,2,2,2] row_mask:0xf bank_mask:0xf
  v_mul_f32_dpp v91, v71, v91 quad_perm:[3,3,3,3] row_mask:0xf bank_mask:0xf
  v_cvt_f64_f32 v[76:77], v88
  v_cvt_f64_f32 v[78:79], v89
  v_cvt_f64_f32 v[80:81], v90
  v_cvt_f64_f32 v[82:83], v91
  ds_add_f64 v84, v[76:77]
  ds_add_f64 v85, v[78:79]
  ds_add_f64 v86, v[80:81]
  ds_add_f64 v87, v[82:83]
  v_and_b32 v70, 0x1fffff, v35
  v_ashrrev_i32 v35, 16, v35
  buffer_load_dwordx2 v[96:97], v70, s[12:15], 0 offen
  v_and_b32 v35, 0x8000ffe0, v35
  s_waitcnt vmcnt(1)
  v_lshlrev_b32 v71, 16, v43
  v_mov_b32_dpp v72, v100 quad_perm:[0,0,0,0] row_mask:0xf bank_mask:0xf
  v_mov_b32_dpp v73, v100 quad_perm:[1,1,1,1] row_mask:0xf bank_mask:0xf
  v_mov_b32_dpp v74, v100 quad_perm:[2,2,2,2] row_mask:0xf bank_mask:0xf
  v_mov_b32_dpp v75, v100 quad_perm:[3,3,3,3] row_mask:0xf bank_mask:0xf
  v_mov_b32_dpp v88, v101 quad_perm:[0,0,0,0] row_mask:0xf bank_mask:0xf
  v_mov_b32_dpp v89, v101 quad_perm:[1,1,1,1] row_mask:0xf bank_mask:0xf
  v_mov_b32_dpp v90, v101 quad_perm:[2,2,2,2] row_mask:0xf bank_mask:0xf
  v_mov_b32_dpp v91, v101 quad_perm:[3,3,3,3] row_mask:0xf bank_mask:0xf
  v_perm_b32 v88, v88, v72, v68
  v_perm_b32 v89, v89, v73, v68
  v_perm_b32 v90, v90, v74, v68
  v_perm_b32 v91, v91, v75, v68
  v_add_u32_dpp v84, v34, v5 quad_perm:[0,0,0,0] row_mask:0xf bank_mask:0xf
  v_add_u32_dpp v85, v34, v5 quad_perm:[1,1,1,1] row_mask:0xf bank_mask:0xf
  v_add_u32_dpp v86, v34, v5 quad_perm:[2,2,2,2] row_mask:0xf bank_mask:0xf
  v_add_u32_dpp v87, v34, v5 quad_perm:[3,3,3,3] row_mask:0xf bank_mask:0xf
  v_mul_f32_dpp v88, v71, v88 quad_perm:[0,0,0,0] row_mask:0xf bank_mask:0xf
  v_mul_f32_dpp v89, v71, v89 quad_perm:[1,1,1,1] row_mask:0xf bank_mask:0xf
  v_mul_f32_dpp v90, v71, v90 quad_perm:[2,2,2,2] row_mask:0xf bank_mask:0xf
  v_mul_f32_dpp v91, v71, v91 quad_perm:[3,3,3,3] row_mask:0xf bank_mask:0xf
  v_cvt_f64_f32 v[76:77], v88
  v_cvt_f64_f32 v[78:79], v89
  v_cvt_f64_f32 v[80:81], v90
  v_cvt_f64_f32 v[82:83], v91
  ds_add_f64 v84, v[76:77]
  ds_add_f64 v85, v[78:79]
  ds_add_f64 v86, v[80:81]
  ds_add_f64 v87, v[82:83]
  s_waitcnt vmcnt(0)
  v_and_b32 v71, 0xffff0000, v43
  v_mov_b32_dpp v72, v96 quad_perm:[0,0,0,0] row_mask:0xf bank_mask:0xf
  v_mov_b32_dpp v73, v96 quad_perm:[1,1,1,1] row_mask:0xf bank_mask:0xf
  v_mov_b32_dpp v74, v96 quad_perm:[2,2,2,2] row_mask:0xf bank_mask:0xf
  v_mov_b32_dpp v75, v96 quad_perm:[3,3,3,3] row_mask:0xf bank_mask:0xf
  v_mov_b32_dpp v88, v97 quad_perm:[0,0,0,0] row_mask:0xf bank_mask:0xf
  v_mov_b32_dpp v89, v97 quad_perm:[1,1,1,1] row_mask:0xf bank_mask:0xf
  v_mov_b32_dpp v90, v97 quad_perm:[2,2,2,2] row_mask:0xf bank_mask:0xf
  v_mov_b32_dpp v91, v97 quad_perm:[3,3,3,3] row_mask:0xf bank_mask:0xf
  v_perm_b32 v88, v88, v72, v68
  v_perm_b32 v89, v89, v73, v68
  v_perm_b32 v90, v90, v74, v68
  v_perm_b32 v91, v91, v75, v68
  v_add_u32_dpp v84, v35, v5 quad_perm:[0,0,0,0] row_mask:0xf bank_mask:0xf
  v_add_u32_dpp v85, v35, v5 quad_perm:[1,1,1,1] row_mask:0xf bank_mask:0xf
  v_add_u32_dpp v86, v35, v5 quad_perm:[2,2,2,2] row_mask:0xf bank_mask:0xf
  v_add_u32_dpp v87, v35, v5 quad_perm:[3,3,3,3] row_mask:0xf bank_mask:0xf
  v_mul_f32_dpp v88, v71, v88 quad_perm:[0,0,0,0] row_mask:0xf bank_mask:0xf
  v_mul_f32_dpp v89, v71, v89 quad_perm:[1,1,1,1] row_mask:0xf bank_mask:0xf
  v_mul_f32_dpp v90, v71, v90 quad_perm:[2,2,2,2] row_mask:0xf bank_mask:0xf
  v_mul_f32_dpp v91, v71, v91 quad_perm:[3,3,3,3] row_mask:0xf bank_mask:0xf
  v_cvt_f64_f32 v[76:77], v88
  v_cvt_f64_f32 v[78:79], v89
  v_cvt_f64_f32 v[80:81], v90
  v_cvt_f64_f32 v[82:83], v91
  ds_add_f64 v84, v[76:77]
  ds_add_f64 v85, v[78:79]
  ds_add_f64 v86, v[80:81]
  ds_add_f64 v87, v[82:83]
  v_min_u32 v70, 64, v44
  v_sub_u32 v44, v44, v70
  v_add_u32 v48, 256, v48
  v_min_u32 v70, 64, v45
  v_sub_u32 v45, v45, v70
  v_add_u32 v49, 256, v49
  v_min_u32 v70, 64, v46
  v_sub_u32 v46, v46, v70
  v_add_u32 v50, 256, v50
  v_min_u32 v70, 64, v47
  v_sub_u32 v47, v47, v70
  v_add_u32 v51, 256, v51
  v_or_b32 v70, v44, v45
  v_or3_b32 v70, v70, v46, v47
  v_cmp_lt_u32 vcc, 0, v70
  s_nop 1
  s_cmp_lg_u64 vcc, 0
  s_cbranch_scc1 L_dir_round
  v_mov_b32 v70, 22524
L_spin_dir:
  ds_read_b32 v71, v70
  s_waitcnt lgkmcnt(0)
  v_readfirstlane_b32 s97, v71
  s_nop 0
  s_cmp_ge_u32 s97, 10
  s_cbranch_scc1 L_spun_dir
  s_sleep 1
  s_branch L_spin_dir
L_spun_dir:
  s_branch L_gather_dir
L_bin_round:
  v_min_u32 v70, 64, v44
  v_sub_u32 v52, v70, v3
  v_lshl_add_u32 v72, v3, 2, v48
  v_cmp_lt_i32 s[88:89], 0, v52
  v_min_u32 v70, 64, v45
  v_sub_u32 v53, v70, v3
  v_lshl_add_u32 v73, v3, 2, v49
  v_cmp_lt_i32 s[90:91], 0, v53
  v_min_u32 v70, 64, v46
  v_sub_u32 v54, v70, v3
  v_lshl_add_u32 v74, v3, 2, v50
  v_cmp_lt_i32 s[92:93], 0, v54
  v_min_u32 v70, 64, v47
  v_sub_u32 v55, v70, v3
  v_lshl_add_u32 v75, v3, 2, v51
  v_cmp_lt_i32 s[94:95], 0, v55
  s_nop 0
  v_cndmask_b32 v92, v69, v72, s[88:89]
  v_cndmask_b32 v93, v69, v73, s[90:91]
  v_cndmask_b32 v94, v69, v74, s[92:93]
  v_cndmask_b32 v66, v69, v75, s[94:95]
  v_lshrrev_b32 v67, 1, v92
  buffer_load_dwordx4 v[20:23], v92, s[4:7], 0 offen
  buffer_load_dwordx2 v[36:37], v67, s[8:11], 0 offen
  v_lshrrev_b32 v67, 1, v93
  buffer_load_dwordx4 v[24:27], v93, s[4:7], 0 offen
  buffer_load_dwordx2 v[38:39], v67, s[8:11], 0 offen
  v_lshrrev_b32 v67, 1, v94
  buffer_load_dwordx4 v[28:31], v94, s[4:7], 0 offen
  buffer_load_dwordx2 v[40:41], v67, s[8:11], 0 offen
L_bin_issued:
  s_setprio 0
  s_cmp_lg_u32 s98, 0
  s_cbranch_scc1 L_bin_noinit
  v_lshlrev_b32 v70, 4, v0
  v_mov_b32 v76, 0
  v_mov_b32 v77, 0
  v_mov_b32 v78, 0
  v_mov_b32 v79, 0
  v_mov_b32 v80, -1
  v_mov_b32 v81, -1
  v_mov_b32 v82, -1
  v_mov_b32 v83, -1
  ds_write_b128 v70, v[76:79]
  ds_write_b128 v70, v[76:79] offset:16384
  v_add_u32 v71, 47616, v70
  ds_write_b128 v71, v[80:83]
  ds_write_b128 v71, v[80:83] offset:16384
  ds_write_b128 v71, v[80:83] offset:32768
  ds_write_b128 v71, v[80:83] offset:49152
  s_waitcnt lgkmcnt(0)
  s_barrier

  s_cmp_lt_u32 s96, 6
  s_cbranch_scc1 L_bin_nogh
  s_pack_ll_b32_b16 s97, s72, s74
  s_pack_hh_b32_b16 s74, s72, s74
  s_mov_b32 s72, s97
  s_pack_ll_b32_b16 s97, s73, s75
  s_pack_hh_b32_b16 s75, s73, s75
  s_mov_b32 s73, s97
  s_pack_ll_b32_b16 s97, s76, s78
  s_pack_hh_b32_b16 s78, s76, s78
  s_mov_b32 s76, s97
  s_pack_ll_b32_b16 s97, s77, s79
  s_pack_hh_b32_b16 s79, s77, s79
  s_mov_b32 s77, s97
  s_pack_ll_b32_b16 s97, s80, s82
  s_pack_hh_b32_b16 s82, s80, s82
  s_mov_b32 s80, s97
  s_pack_ll_b32_b16 s97, s81, s83
  s_pack_hh_b32_b16 s83, s81, s83
  s_mov_b32 s81, s97
  s_pack_ll_b32_b16 s97, s84, s86
  s_pack_hh_b32_b16 s86, s84, s86
  s_mov_b32 s84, s97
  s_pack_ll_b32_b16 s97, s85, s87
  s_pack_hh_b32_b16 s87, s85, s87
  s_mov_b32 s85, s97
  s_pack_ll_b32_b16 s97, s52, s54
  s_pack_hh_b32_b16 s54, s52, s54
  s_mov_b32 s52, s97
  s_pack_ll_b32_b16 s97, s53, s55
  s_pack_hh_b32_b16 s55, s53, s55
  s_mov_b32 s53, s97
  s_pack_ll_b32_b16 s97, s56, s58
  s_pack_hh_b32_b16 s58, s56, s58
  s_mov_b32 s56, s97
  s_pack_ll_b32_b16 s97, s57, s59
  s_pack_hh_b32_b16 s59, s57, s59
  s_mov_b32 s57, s97
  s_pack_ll_b32_b16 s97, s60, s62
  s_pack_hh_b32_b16 s62, s60, s62
  s_mov_b32 s60, s97
  s_pack_ll_b32_b16 s97, s61, s63
  s_pack_hh_b32_b16 s63, s61, s63
  s_mov_b32 s61, s97
  s_pack_ll_b32_b16 s97, s64, s66
  s_pack_hh_b32_b16 s66, s64, s66
  s_mov_b32 s64, s97
  s_pack_ll_b32_b16 s97, s65, s67
  s_pack_hh_b32_b16 s67, s65, s67
  s_mov_b32 s65, s97
  s_and_b32 s35, s27, 0xffff0000
  s_lshl_b32 s34, s27, 16
  s_and_b32 s51, s43, 0xffff0000
  s_lshl_b32 s50, s43, 16
  s_and_b32 s33, s26, 0xffff0000
  s_lshl_b32 s32, s26, 16
  s_and_b32 s49, s42, 0xffff0000
  s_lshl_b32 s48, s42, 16
  s_and_b32 s31, s25, 0xffff0000
  s_lshl_b32 s30, s25, 16
  s_and_b32 s47, s41, 0xffff0000
  s_lshl_b32 s46, s41, 16
  s_and_b32 s29, s24, 0xffff0000
  s_lshl_b32 s28, s24, 16
  s_and_b32 s45, s40, 0xffff0000
  s_lshl_b32 s44, s40, 16
  s_and_b32 s27, s23, 0xffff0000
  s_lshl_b32 s26, s23, 16
  s_and_b32 s43, s39, 0xffff0000
  s_lshl_b32 s42, s39, 16
  s_and_b32 s25, s22, 0xffff0000
  s_lshl_b32 s24, s22, 16
  s_and_b32 s41, s38, 0xffff0000
  s_lshl_b32 s40, s38, 16
  s_and_b32 s23, s21, 0xffff0000
  s_lshl_b32 s22, s21, 16
  s_and_b32 s39, s37, 0xffff0000
  s_lshl_b32 s38, s37, 16
  s_and_b32 s21, s20, 0xffff0000
  s_lshl_b32 s20, s20, 16
  s_and_b32 s37, s36, 0xffff0000
  s_lshl_b32 s36, s36, 16
  s_waitcnt vmcnt(6)
  v_lshlrev_b32 v9, 16, v9
  s_lshl_b32 s97, s68, 16
      s_and_b32 s99, s68, 0xffff0000
      v_subrev_f32 v70, s97, v9
      v_subrev_f32 v71, s99, v9
      v_cvt_pk_bf16_f32 v72, v70, v71
      v_lshlrev_b32 v70, 16, v72
      v_and_b32 v71, 0xffff0000, v72
      v_mul_f32 v70, v70, v70
      v_mul_f32 v71, v71, v71
      v_cvt_pk_bf16_f32 v72, v70, v71
      v_lshlrev_b32 v70, 16, v72
      v_and_b32 v71, 0xffff0000, v72
      v_mul_f32 v70, 0xc1200000, v70
      v_mul_f32 v71, 0xc1200000, v71
      v_cvt_pk_bf16_f32 v72, v70, v71
      v_lshlrev_b32 v70, 16, v72
      v_and_b32 v71, 0xffff0000, v72
      v_mul_f32 v70, 0x3fb8aa3b, v70
      v_mul_f32 v71, 0x3fb8aa3b, v71
      v_exp_f32 v70, v70
      v_exp_f32 v71, v71
      s_nop 0
      v_cvt_pk_bf16_f32 v80, v70, v71
  s_lshl_b32 s97, s69, 16
      s_and_b32 s99, s69, 0xffff0000
      v_subrev_f32 v70, s97, v9
      v_subrev_f32 v71, s99, v9
      v_cvt_pk_bf16_f32 v72, v70, v71
      v_lshlrev_b32 v70, 16, v72
      v_and_b32 v71, 0xffff0000, v72
      v_mul_f32 v70, v70, v70
      v_mul_f32 v71, v71, v71
      v_cvt_pk_bf16_f32 v72, v70, v71
      v_lshlrev_b32 v70, 16, v72
      v_and_b32 v71, 0xffff0000, v72
      v_mul_f32 v70, 0xc1200000, v70
      v_mul_f32 v71, 0xc1200000, v71
      v_cvt_pk_bf16_f32 v72, v70, v71
      v_lshlrev_b32 v70, 16, v72
      v_and_b32 v71, 0xffff0000, v72
      v_mul_f32 v70, 0x3fb8aa3b, v70
      v_mul_f32 v71, 0x3fb8aa3b, v71
      v_exp_f32 v70, v70
      v_exp_f32 v71, v71
      s_nop 0
      v_cvt_pk_bf16_f32 v81, v70, v71
  s_lshl_b32 s97, s70, 16
      s_and_b32 s99, s70, 0xffff0000
      v_subrev_f32 v70, s97, v9
      v_subrev_f32 v71, s99, v9
      v_cvt_pk_bf16_f32 v72, v70, v71
      v_lshlrev_b32 v70, 16, v72
      v_and_b32 v71, 0xffff0000, v72
      v_mul_f32 v70, v70, v70
      v_mul_f32 v71, v71, v71
      v_cvt_pk_bf16_f32 v72, v70, v71
      v_lshlrev_b32 v70, 16, v72
      v_and_b32 v71, 0xffff0000, v72
      v_mul_f32 v70, 0xc1200000, v70
      v_mul_f32 v71, 0xc1200000, v71
      v_cvt_pk_bf16_f32 v72, v70, v71
      v_lshlrev_b32 v70, 16, v72
      v_and_b32 v71, 0xffff0000, v72
      v_mul_f32 v70, 0x3fb8aa3b, v70
      v_mul_f32 v71, 0x3fb8aa3b, v71
      v_exp_f32 v70, v70
      v_exp_f32 v71, v71
      s_nop 0
      v_cvt_pk_bf16_f32 v82, v70, v71
  s_lshl_b32 s97, s71, 16
      s_and_b32 s99, s71, 0xffff0000
      v_subrev_f32 v70, s97, v9
      v_subrev_f32 v71, s99, v9
      v_cvt_pk_bf16_f32 v72, v70, v71
      v_lshlrev_b32 v70, 16, v72
      v_and_b32 v71, 0xffff0000, v72
      v_mul_f32 v70, v70, v70
      v_mul_f32 v71, v71, v71
      v_cvt_pk_bf16_f32 v72, v70, v71
      v_lshlrev_b32 v70, 16, v72
      v_and_b32 v71, 0xffff0000, v72
      v_mul_f32 v70, 0xc1200000, v70
      v_mul_f32 v71, 0xc1200000, v71
      v_cvt_pk_bf16_f32 v72, v70, v71
      v_lshlrev_b32 v70, 16, v72
      v_and_b32 v71, 0xffff0000, v72
      v_mul_f32 v70, 0x3fb8aa3b, v70
      v_mul_f32 v71, 0x3fb8aa3b, v71
      v_exp_f32 v70, v70
      v_exp_f32 v71, v71
      s_nop 0
      v_cvt_pk_bf16_f32 v83, v70, v71
  v_dot2_f32_bf16 v12, v80, s72, 0
  v_dot2_f32_bf16 v12, v81, s76, v12
  v_dot2_f32_bf16 v12, v82, s80, v12
  v_dot2_f32_bf16 v12, v83, s84, v12
  v_dot2_f32_bf16 v13, v80, s74, 0
  v_dot2_f32_bf16 v13, v81, s78, v13
  v_dot2_f32_bf16 v13, v82, s82, v13
  v_dot2_f32_bf16 v13, v83, s86, v13
  v_dot2_f32_bf16 v14, v80, s73, 0
  v_dot2_f32_bf16 v14, v81, s77, v14
  v_dot2_f32_bf16 v14, v82, s81, v14
  v_dot2_f32_bf16 v14, v83, s85, v14
  v_dot2_f32_bf16 v15, v80, s75, 0
  v_dot2_f32_bf16 v15, v81, s79, v15
  v_dot2_f32_bf16 v15, v82, s83, v15
  v_dot2_f32_bf16 v15, v83, s87, v15
  v_dot2_f32_bf16 v16, v80, s52, 0
  v_dot2_f32_bf16 v16, v81, s56, v16
  v_dot2_f32_bf16 v16, v82, s60, v16
  v_dot2_f32_bf16 v16, v83, s64, v16
  v_dot2_f32_bf16 v17, v80, s54, 0
  v_dot2_f32_bf16 v17, v81, s58, v17
  v_dot2_f32_bf16 v17, v82, s62, v17
  v_dot2_f32_bf16 v17, v83, s66, v17
  v_dot2_f32_bf16 v18, v80, s53, 0
  v_dot2_f32_bf16 v18, v81, s57, v18
  v_dot2_f32_bf16 v18, v82, s61, v18
  v_dot2_f32_bf16 v18, v83, s65, v18
  v_dot2_f32_bf16 v19, v80, s55, 0
  v_dot2_f32_bf16 v19, v81, s59, v19
  v_dot2_f32_bf16 v19, v82, s63, v19
  v_dot2_f32_bf16 v19, v83, s67, v19
  s_nop 2
  v_cvt_pk_bf16_f32 v70, v16, v17
  v_cvt_pk_bf16_f32 v71, v18, v19
  v_lshlrev_b32 v16, 16, v70
  v_and_b32 v17, 0xffff0000, v70
  v_lshlrev_b32 v18, 16, v71
  v_and_b32 v19, 0xffff0000, v71

L_bin_nogh:
  s_mov_b32 s98, 1
L_bin_noinit:
  s_brev_b32 s62, 1
  v_max_u32 v70, v44, v45
  v_max3_u32 v70, v70, v46, v47
  v_cmp_lt_u32 vcc, 64, v70
  s_nop 1
  s_cmp_eq_u64 vcc, 0
  s_cbranch_scc1 L_bin_nospare
  v_mov_b32 v56, 0
  v_mov_b32 v57, 0
  v_mov_b32 v58, -1
  v_cmp_lt_u32 vcc, 64, v47
  v_subrev_u32 v70, 64, v47
  v_add_u32 v71, 256, v51
  v_cndmask_b32 v56, v56, v70, vcc
  v_cndmask_b32 v57, v57, v71, vcc
  v_cndmask_b32 v58, v58, 3, vcc
  v_cmp_lt_u32 vcc, 64, v46
  v_subrev_u32 v70, 64, v46
  v_add_u32 v71, 256, v50
  v_cndmask_b32 v56, v56, v70, vcc
  v_cndmask_b32 v57, v57, v71, vcc
  v_cndmask_b32 v58, v58, 2, vcc
  v_cmp_lt_u32 vcc, 64, v45
  v_subrev_u32 v70, 64, v45
  v_add_u32 v71, 256, v49
  v_cndmask_b32 v56, v56, v70, vcc
  v_cndmask_b32 v57, v57, v71, vcc
  v_cndmask_b32 v58, v58, 1, vcc
  v_cmp_lt_u32 vcc, 64, v44
  v_subrev_u32 v70, 64, v44
  v_add_u32 v71, 256, v48
  v_cndmask_b32 v56, v56, v70, vcc
  v_cndmask_b32 v57, v57, v71, vcc
  v_cndmask_b32 v58, v58, 0, vcc
  v_min_u32 v56, 64, v56
  v_sub_u32 v59, v56, v3
  v_lshl_add_u32 v57, v3, 2, v57
  v_cmp_lt_i32 vcc, 0, v59
  s_nop 1
  v_cndmask_b32 v57, v69, v57, vcc
  v_lshrrev_b32 v70, 1, v57
  buffer_load_dwordx4 v[60:63], v57, s[4:7], 0 offen
  buffer_load_dwordx2 v[64:65], v70, s[8:11], 0 offen
  v_cmp_eq_u32 vcc, 0, v58
  v_lshlrev_b32 v70, 2, v56
  s_nop 0
  v_cndmask_b32 v71, 0, v70, vcc
  v_cndmask_b32 v70, 0, v56, vcc
  v_add_u32 v48, v48, v71
  v_sub_u32 v44, v44, v70
  v_cmp_eq_u32 vcc, 1, v58
  v_lshlrev_b32 v70, 2, v56
  s_nop 0
  v_cndmask_b32 v71, 0, v70, vcc
  v_cndmask_b32 v70, 0, v56, vcc
  v_add_u32 v49, v49, v71
  v_sub_u32 v45, v45, v70
  v_cmp_eq_u32 vcc, 2, v58
  v_lshlrev_b32 v70, 2, v56
  s_nop 0
  v_cndmask_b32 v71, 0, v70, vcc
  v_cndmask_b32 v70, 0, v56, vcc
  v_add_u32 v50, v50, v71
  v_sub_u32 v46, v46, v70
  v_cmp_eq_u32 vcc, 3, v58
  v_lshlrev_b32 v70, 2, v56
  s_nop 0
  v_cndmask_b32 v71, 0, v70, vcc
  v_cndmask_b32 v70, 0, v56, vcc
  v_add_u32 v51, v51, v71
  v_sub_u32 v47, v47, v70
  s_waitcnt vmcnt(0)
  v_cmp_lt_i32 s[88:89], 0, v59
  v_cmp_lt_i32 s[90:91], 1, v59
  v_cmp_lt_i32 s[92:93], 2, v59
  v_cmp_lt_i32 s[94:95], 3, v59
  v_cndmask_b32 v60, -1, v60, s[88:89]
  v_cndmask_b32 v61, -1, v61, s[90:91]
  v_cndmask_b32 v62, -1, v62, s[92:93]
  v_cndmask_b32 v63, -1, v63, s[94:95]
  v_and_b32 v70, 0x1fffff, v60
  v_ashrrev_i32 v60, 16, v60
  buffer_load_dwordx2 v[112:113], v70, s[12:15], 0 offen
  v_and_b32 v60, 0x8000ffe0, v60
  v_and_b32 v70, 0x1fffff, v61
  v_ashrrev_i32 v61, 16, v61
  buffer_load_dwordx2 v[114:115], v70, s[12:15], 0 offen
  v_and_b32 v61, 0x8000ffe0, v61
  v_and_b32 v70, 0x1fffff, v62
  v_ashrrev_i32 v62, 16, v62
  buffer_load_dwordx2 v[116:117], v70, s[12:15], 0 offen
  v_and_b32 v62, 0x8000ffe0, v62
  v_and_b32 v70, 0x1fffff, v63
  v_ashrrev_i32 v63, 16, v63
  buffer_load_dwordx2 v[118:119], v70, s[12:15], 0 offen
  v_and_b32 v63, 0x8000ffe0, v63
  s_waitcnt vmcnt(0)
  v_lshlrev_b32 v71, 16, v64
  v_mov_b32_dpp v72, v112 quad_perm:[0,0,0,0] row_mask:0xf bank_mask:0xf
  v_mov_b32_dpp v73, v112 quad_perm:[1,1,1,1] row_mask:0xf bank_mask:0xf
  v_mov_b32_dpp v74, v112 quad_perm:[2,2,2,2] row_mask:0xf bank_mask:0xf
  v_mov_b32_dpp v75, v112 quad_perm:[3,3,3,3] row_mask:0xf bank_mask:0xf
  v_mov_b32_dpp v88, v113 quad_perm:[0,0,0,0] row_mask:0xf bank_mask:0xf
  v_mov_b32_dpp v89, v113 quad_perm:[1,1,1,1] row_mask:0xf bank_mask:0xf
  v_mov_b32_dpp v90, v113 quad_perm:[2,2,2,2] row_mask:0xf bank_mask:0xf
  v_mov_b32_dpp v91, v113 quad_perm:[3,3,3,3] row_mask:0xf bank_mask:0xf
  v_perm_b32 v88, v88, v72, v68
  v_perm_b32 v89, v89, v73, v68
  v_perm_b32 v90, v90, v74, v68
  v_perm_b32 v91, v91, v75, v68
  v_add_u32_dpp v84, v60, v5 quad_perm:[0,0,0,0] row_mask:0xf bank_mask:0xf
  v_add_u32_dpp v85, v60, v5 quad_perm:[1,1,1,1] row_mask:0xf bank_mask:0xf
  v_add_u32_dpp v86, v60, v5 quad_perm:[2,2,2,2] row_mask:0xf bank_mask:0xf
  v_add_u32_dpp v87, v60, v5 quad_perm:[3,3,3,3] row_mask:0xf bank_mask:0xf
  v_mul_f32_dpp v88, v71, v88 quad_perm:[0,0,0,0] row_mask:0xf bank_mask:0xf
  v_mul_f32_dpp v89, v71, v89 quad_perm:[1,1,1,1] row_mask:0xf bank_mask:0xf
  v_mul_f32_dpp v90, v71, v90 quad_perm:[2,2,2,2] row_mask:0xf bank_mask:0xf
  v_mul_f32_dpp v91, v71, v91 quad_perm:[3,3,3,3] row_mask:0xf bank_mask:0xf
  v_cvt_f64_f32 v[76:77], v88
  v_cvt_f64_f32 v[78:79], v89
  v_cvt_f64_f32 v[80:81], v90
  v_cvt_f64_f32 v[82:83], v91
  ds_add_f64 v84, v[76:77]
  ds_add_f64 v85, v[78:79]
  ds_add_f64 v86, v[80:81]
  ds_add_f64 v87, v[82:83]
  v_and_b32 v71, 0xffff0000, v64
  v_mov_b32_dpp v72, v114 quad_perm:[0,0,0,0] row_mask:0xf bank_mask:0xf
  v_mov_b32_dpp v73, v114 quad_perm:[1,1,1,1] row_mask:0xf bank_mask:0xf
  v_mov_b32_dpp v74, v114 quad_perm:[2,2,2,2] row_mask:0xf bank_mask:0xf
  v_mov_b32_dpp v75, v114 quad_perm:[3,3,3,3] row_mask:0xf bank_mask:0xf
  v_mov_b32_dpp v88, v115 quad_perm:[0,0,0,0] row_mask:0xf bank_mask:0xf
  v_mov_b32_dpp v89, v115 quad_perm:[1,1,1,1] row_mask:0xf bank_mask:0xf
  v_mov_b32_dpp v90, v115 quad_perm:[2,2,2,2] row_mask:0xf bank_mask:0xf
  v_mov_b32_dpp v91, v115 quad_perm:[3,3,3,3] row_mask:0xf bank_mask:0xf
  v_perm_b32 v88, v88, v72, v68
  v_perm_b32 v89, v89, v73, v68
  v_perm_b32 v90, v90, v74, v68
  v_perm_b32 v91, v91, v75, v68
  v_add_u32_dpp v84, v61, v5 quad_perm:[0,0,0,0] row_mask:0xf bank_mask:0xf
  v_add_u32_dpp v85, v61, v5 quad_perm:[1,1,1,1] row_mask:0xf bank_mask:0xf
  v_add_u32_dpp v86, v61, v5 quad_perm:[2,2,2,2] row_mask:0xf bank_mask:0xf
  v_add_u32_dpp v87, v61, v5 quad_perm:[3,3,3,3] row_mask:0xf bank_mask:0xf
  v_mul_f32_dpp v88, v71, v88 quad_perm:[0,0,0,0] row_mask:0xf bank_mask:0xf
  v_mul_f32_dpp v89, v71, v89 quad_perm:[1,1,1,1] row_mask:0xf bank_mask:0xf
  v_mul_f32_dpp v90, v71, v90 quad_perm:[2,2,2,2] row_mask:0xf bank_mask:0xf
  v_mul_f32_dpp v91, v71, v91 quad_perm:[3,3,3,3] row_mask:0xf bank_mask:0xf
  v_cvt_f64_f32 v[76:77], v88
  v_cvt_f64_f32 v[78:79], v89
  v_cvt_f64_f32 v[80:81], v90
  v_cvt_f64_f32 v[82:83], v91
  ds_add_f64 v84, v[76:77]
  ds_add_f64 v85, v[78:79]
  ds_add_f64 v86, v[80:81]
  ds_add_f64 v87, v[82:83]
  v_lshlrev_b32 v71, 16, v65
  v_mov_b32_dpp v72, v116 quad_perm:[0,0,0,0] row_mask:0xf bank_mask:0xf
  v_mov_b32_dpp v73, v116 quad_perm:[1,1,1,1] row_mask:0xf bank_mask:0xf
  v_mov_b32_dpp v74, v116 quad_perm:[2,2,2,2] row_mask:0xf bank_mask:0xf
  v_mov_b32_dpp v75, v116 quad_perm:[3,3,3,3] row_mask:0xf bank_mask:0xf
  v_mov_b32_dpp v88, v117 quad_perm:[0,0,0,0] row_mask:0xf bank_mask:0xf
  v_mov_b32_dpp v89, v117 quad_perm:[1,1,1,1] row_mask:0xf bank_mask:0xf
  v_mov_b32_dpp v90, v117 quad_perm:[2,2,2,2] row_mask:0xf bank_mask:0xf
  v_mov_b32_dpp v91, v117 quad_perm:[3,3,3,3] row_mask:0xf bank_mask:0xf
  v_perm_b32 v88, v88, v72, v68
  v_perm_b32 v89, v89, v73, v68
  v_perm_b32 v90, v90, v74, v68
  v_perm_b32 v91, v91, v75, v68
  v_add_u32_dpp v84, v62, v5 quad_perm:[0,0,0,0] row_mask:0xf bank_mask:0xf
  v_add_u32_dpp v85, v62, v5 quad_perm:[1,1,1,1] row_mask:0xf bank_mask:0xf
  v_add_u32_dpp v86, v62, v5 quad_perm:[2,2,2,2] row_mask:0xf bank_mask:0xf
  v_add_u32_dpp v87, v62, v5 quad_perm:[3,3,3,3] row_mask:0xf bank_mask:0xf
  v_mul_f32_dpp v88, v71, v88 quad_perm:[0,0,0,0] row_mask:0xf bank_mask:0xf
  v_mul_f32_dpp v89, v71, v89 quad_perm:[1,1,1,1] row_mask:0xf bank_mask:0xf
  v_mul_f32_dpp v90, v71, v90 quad_perm:[2,2,2,2] row_mask:0xf bank_mask:0xf
  v_mul_f32_dpp v91, v71, v91 quad_perm:[3,3,3,3] row_mask:0xf bank_mask:0xf
  v_cvt_f64_f32 v[76:77], v88
  v_cvt_f64_f32 v[78:79], v89
  v_cvt_f64_f32 v[80:81], v90
  v_cvt_f64_f32 v[82:83], v91
  ds_add_f64 v84, v[76:77]
  ds_add_f64 v85, v[78:79]
  ds_add_f64 v86, v[80:81]
  ds_add_f64 v87, v[82:83]
  v_and_b32 v71, 0xffff0000, v65
  v_mov_b32_dpp v72, v118 quad_perm:[0,0,0,0] row_mask:0xf bank_mask:0xf
  v_mov_b32_dpp v73, v118 quad_perm:[1,1,1,1] row_mask:0xf bank_mask:0xf
  v_mov_b32_dpp v74, v118 quad_perm:[2,2,2,2] row_mask:0xf bank_mask:0xf
  v_mov_b32_dpp v75, v118 quad_perm:[3,3,3,3] row_mask:0xf bank_mask:0xf
  v_mov_b32_dpp v88, v119 quad_perm:[0,0,0,0] row_mask:0xf bank_mask:0xf
  v_mov_b32_dpp v89, v119 quad_perm:[1,1,1,1] row_mask:0xf bank_mask:0xf
  v_mov_b32_dpp v90, v119 quad_perm:[2,2,2,2] row_mask:0xf bank_mask:0xf
  v_mov_b32_dpp v91, v119 quad_perm:[3,3,3,3] row_mask:0xf bank_mask:0xf
  v_perm_b32 v88, v88, v72, v68
  v_perm_b32 v89, v89, v73, v68
  v_perm_b32 v90, v90, v74, v68
  v_perm_b32 v91, v91, v75, v68
  v_add_u32_dpp v84, v63, v5 quad_perm:[0,0,0,0] row_mask:0xf bank_mask:0xf
  v_add_u32_dpp v85, v63, v5 quad_perm:[1,1,1,1] row_mask:0xf bank_mask:0xf
  v_add_u32_dpp v86, v63, v5 quad_perm:[2,2,2,2] row_mask:0xf bank_mask:0xf
  v_add_u32_dpp v87, v63, v5 quad_perm:[3,3,3,3] row_mask:0xf bank_mask:0xf
  v_mul_f32_dpp v88, v71, v88 quad_perm:[0,0,0,0] row_mask:0xf bank_mask:0xf
  v_mul_f32_dpp v89, v71, v89 quad_perm:[1,1,1,1] row_mask:0xf bank_mask:0xf
  v_mul_f32_dpp v90, v71, v90 quad_perm:[2,2,2,2] row_mask:0xf bank_mask:0xf
  v_mul_f32_dpp v91, v71, v91 quad_perm:[3,3,3,3] row_mask:0xf bank_mask:0xf
  v_cvt_f64_f32 v[76:77], v88
  v_cvt_f64_f32 v[78:79], v89
  v_cvt_f64_f32 v[80:81], v90
  v_cvt_f64_f32 v[82:83], v91
  ds_add_f64 v84, v[76:77]
  ds_add_f64 v85, v[78:79]
  ds_add_f64 v86, v[80:81]
  ds_add_f64 v87, v[82:83]
L_bin_nospare:
  s_mov_b64 s[54:55], 0
  s_waitcnt vmcnt(5)
  v_lshrrev_b32 v67, 1, v66
  buffer_load_dwordx4 v[32:35], v66, s[4:7], 0 offen
  buffer_load_dwordx2 v[42:43], v67, s[8:11], 0 offen
  v_cmp_lt_i32 s[88:89], 0, v52
  v_cmp_lt_i32 s[90:91], 1, v52
  v_cmp_lt_i32 s[92:93], 2, v52
  v_cmp_lt_i32 s[94:95], 3, v52
  v_cndmask_b32 v20, -1, v20, s[88:89]
  v_cndmask_b32 v21, -1, v21, s[90:91]
  v_cndmask_b32 v22, -1, v22, s[92:93]
  v_cndmask_b32 v23, -1, v23, s[94:95]
  v_and_b32 v112, 0x1fffff, v20
  v_and_b32 v113, 0x1fffff, v21
  v_and_b32 v114, 0x1fffff, v22
  v_and_b32 v115, 0x1fffff, v23
  v_mul_hi_u32_u24 v112, 0x140783, v112
  v_mul_hi_u32_u24 v113, 0x140783, v113
  v_mul_hi_u32_u24 v114, 0x140783, v114
  v_mul_hi_u32_u24 v115, 0x140783, v115
  v_lshlrev_b32 v112, 2, v112
  v_lshlrev_b32 v113, 2, v113
  v_lshlrev_b32 v114, 2, v114
  v_lshlrev_b32 v115, 2, v115
  v_and_or_b32 v112, v20, s62, v112
  v_and_or_b32 v113, v21, s62, v113
  v_and_or_b32 v114, v22, s62, v114
  v_and_or_b32 v115, v23, s62, v115
  ds_add_rtn_u32 v96, v112, v6 offset:20480
  ds_add_rtn_u32 v97, v113, v6 offset:20480
  ds_add_rtn_u32 v98, v114, v6 offset:20480
  ds_add_rtn_u32 v99, v115, v6 offset:20480
  s_waitcnt vmcnt(5)
  v_cmp_lt_i32 s[88:89], 0, v53
  v_cmp_lt_i32 s[90:91], 1, v53
  v_cmp_lt_i32 s[92:93], 2, v53
  v_cmp_lt_i32 s[94:95], 3, v53
  v_cndmask_b32 v24, -1, v24, s[88:89]
  v_cndmask_b32 v25, -1, v25, s[90:91]
  v_cndmask_b32 v26, -1, v26, s[92:93]
  v_cndmask_b32 v27, -1, v27, s[94:95]
  v_and_b32 v116, 0x1fffff, v24
  v_and_b32 v117, 0x1fffff, v25
  v_and_b32 v118, 0x1fffff, v26
  v_and_b32 v119, 0x1fffff, v27
  v_mul_hi_u32_u24 v116, 0x140783, v116
  v_mul_hi_u32_u24 v117, 0x140783, v117
  v_mul_hi_u32_u24 v118, 0x140783, v118
  v_mul_hi_u32_u24 v119, 0x140783, v119
  v_lshlrev_b32 v116, 2, v116
  v_lshlrev_b32 v117, 2, v117
  v_lshlrev_b32 v118, 2, v118
  v_lshlrev_b32 v119, 2, v119
  v_and_or_b32 v116, v24, s62, v116
  v_and_or_b32 v117, v25, s62, v117
  v_and_or_b32 v118, v26, s62, v118
  v_and_or_b32 v119, v27, s62, v119
  ds_add_rtn_u32 v100, v116, v6 offset:20480
  ds_add_rtn_u32 v101, v117, v6 offset:20480
  ds_add_rtn_u32 v102, v118, v6 offset:20480
  ds_add_rtn_u32 v103, v119, v6 offset:20480
  s_waitcnt vmcnt(6) lgkmcnt(4)
  v_and_or_b32 v96, v20, s62, v96
  v_and_or_b32 v97, v21, s62, v97
  v_and_or_b32 v98, v22, s62, v98
  v_and_or_b32 v99, v23, s62, v99
  v_cmp_gt_u32 s[88:89], 32, v96
  v_cmp_gt_u32 s[90:91], 32, v97
  v_cmp_gt_u32 s[92:93], 32, v98
  v_cmp_gt_u32 s[94:95], 32, v99
  v_lshlrev_b32 v72, 2, v96
  v_lshlrev_b32 v73, 2, v97
  v_lshlrev_b32 v74, 2, v98
  v_lshlrev_b32 v75, 2, v99
  v_lshl_add_u32 v72, v112, 5, v72
  v_lshl_add_u32 v73, v113, 5, v73
  v_lshl_add_u32 v74, v114, 5, v74
  v_lshl_add_u32 v75, v115, 5, v75
  v_cndmask_b32 v72, v69, v72, s[88:89]
  v_cndmask_b32 v73, v69, v73, s[90:91]
  v_cndmask_b32 v74, v69, v74, s[92:93]
  v_cndmask_b32 v75, v69, v75, s[94:95]
  v_lshrrev_b32 v76, 1, v72
  v_lshrrev_b32 v77, 1, v73
  v_lshrrev_b32 v78, 1, v74
  v_lshrrev_b32 v79, 1, v75
  ds_write_b32 v72, v20 offset:47616
  ds_write_b32 v73, v21 offset:47616
  ds_write_b32 v74, v22 offset:47616
  ds_write_b32 v75, v23 offset:47616
  ds_write_b16 v76, v36 offset:22528
  ds_write_b16_d16_hi v77, v36 offset:22528
  ds_write_b16 v78, v37 offset:22528
  ds_write_b16_d16_hi v79, v37 offset:22528
  v_cmp_le_i32 s[88:89], 32, v96
  v_cmp_le_i32 s[90:91], 32, v97
  v_cmp_le_i32 s[92:93], 32, v98
  v_cmp_le_i32 s[94:95], 32, v99
  s_or_b64 s[88:89], s[88:89], s[90:91]
  s_or_b64 s[92:93], s[92:93], s[94:95]
  s_or_b64 s[54:55], s[54:55], s[88:89]
  s_or_b64 s[54:55], s[54:55], s[92:93]
  s_waitcnt vmcnt(3)
  v_cmp_lt_i32 s[88:89], 0, v54
  v_cmp_lt_i32 s[90:91], 1, v54
  v_cmp_lt_i32 s[92:93], 2, v54
  v_cmp_lt_i32 s[94:95], 3, v54
  v_cndmask_b32 v28, -1, v28, s[88:89]
  v_cndmask_b32 v29, -1, v29, s[90:91]
  v_cndmask_b32 v30, -1, v30, s[92:93]
  v_cndmask_b32 v31, -1, v31, s[94:95]
  v_and_b32 v112, 0x1fffff, v28
  v_and_b32 v113, 0x1fffff, v29
  v_and_b32 v114, 0x1fffff, v30
  v_and_b32 v115, 0x1fffff, v31
  v_mul_hi_u32_u24 v112, 0x140783, v112
  v_mul_hi_u32_u24 v113, 0x140783, v113
  v_mul_hi_u32_u24 v114, 0x140783, v114
  v_mul_hi_u32_u24 v115, 0x140783, v115
  v_lshlrev_b32 v112, 2, v112
  v_lshlrev_b32 v113, 2, v113
  v_lshlrev_b32 v114, 2, v114
  v_lshlrev_b32 v115, 2, v115
  v_and_or_b32 v112, v28, s62, v112
  v_and_or_b32 v113, v29, s62, v113
  v_and_or_b32 v114, v30, s62, v114
  v_and_or_b32 v115, v31, s62, v115
  ds_add_rtn_u32 v104, v112, v6 offset:20480
  ds_add_rtn_u32 v105, v113, v6 offset:20480
  ds_add_rtn_u32 v106, v114, v6 offset:20480
  ds_add_rtn_u32 v107, v115, v6 offset:20480
  s_waitcnt vmcnt(4) lgkmcnt(12)
  v_and_or_b32 v100, v24, s62, v100
  v_and_or_b32 v101, v25, s62, v101
  v_and_or_b32 v102, v26, s62, v102
  v_and_or_b32 v103, v27, s62, v103
  v_cmp_gt_u32 s[88:89], 32, v100
  v_cmp_gt_u32 s[90:91], 32, v101
  v_cmp_gt_u32 s[92:93], 32, v102
  v_cmp_gt_u32 s[94:95], 32, v103
  v_lshlrev_b32 v72, 2, v100
  v_lshlrev_b32 v73, 2, v101
  v_lshlrev_b32 v74, 2, v102
  v_lshlrev_b32 v75, 2, v103
  v_lshl_add_u32 v72, v116, 5, v72
  v_lshl_add_u32 v73, v117, 5, v73
  v_lshl_add_u32 v74, v118, 5, v74
  v_lshl_add_u32 v75, v119, 5, v75
  v_cndmask_b32 v72, v69, v72, s[88:89]
  v_cndmask_b32 v73, v69, v73, s[90:91]
  v_cndmask_b32 v74, v69, v74, s[92:93]
  v_cndmask_b32 v75, v69, v75, s[94:95]
  v_lshrrev_b32 v76, 1, v72
  v_lshrrev_b32 v77, 1, v73
  v_lshrrev_b32 v78, 1, v74
  v_lshrrev_b32 v79, 1, v75
  ds_write_b32 v72, v24 offset:47616
  ds_write_b32 v73, v25 offset:47616
  ds_write_b32 v74, v26 offset:47616
  ds_write_b32 v75, v27 offset:47616
  ds_write_b16 v76, v38 offset:22528
  ds_write_b16_d16_hi v77, v38 offset:22528
  ds_write_b16 v78, v39 offset:22528
  ds_write_b16_d16_hi v79, v39 offset:22528
  v_cmp_le_i32 s[88:89], 32, v100
  v_cmp_le_i32 s[90:91], 32, v101
  v_cmp_le_i32 s[92:93], 32, v102
  v_cmp_le_i32 s[94:95], 32, v103
  s_or_b64 s[88:89], s[88:89], s[90:91]
  s_or_b64 s[92:93], s[92:93], s[94:95]
  s_or_b64 s[54:55], s[54:55], s[88:89]
  s_or_b64 s[54:55], s[54:55], s[92:93]
  s_waitcnt vmcnt(1)
  v_cmp_lt_i32 s[88:89], 0, v55
  v_cmp_lt_i32 s[90:91], 1, v55
  v_cmp_lt_i32 s[92:93], 2, v55
  v_cmp_lt_i32 s[94:95], 3, v55
  v_cndmask_b32 v32, -1, v32, s[88:89]
  v_cndmask_b32 v33, -1, v33, s[90:91]
  v_cndmask_b32 v34, -1, v34, s[92:93]
  v_cndmask_b32 v35, -1, v35, s[94:95]
  v_and_b32 v116, 0x1fffff, v32
  v_and_b32 v117, 0x1fffff, v33
  v_and_b32 v118, 0x1fffff, v34
  v_and_b32 v119, 0x1fffff, v35
  v_mul_hi_u32_u24 v116, 0x140783, v116
  v_mul_hi_u32_u24 v117, 0x140783, v117
  v_mul_hi_u32_u24 v118, 0x140783, v118
  v_mul_hi_u32_u24 v119, 0x140783, v119
  v_lshlrev_b32 v116, 2, v116
  v_lshlrev_b32 v117, 2, v117
  v_lshlrev_b32 v118, 2, v118
  v_lshlrev_b32 v119, 2, v119
  v_and_or_b32 v116, v32, s62, v116
  v_and_or_b32 v117, v33, s62, v117
  v_and_or_b32 v118, v34, s62, v118
  v_and_or_b32 v119, v35, s62, v119
  ds_add_rtn_u32 v108, v116, v6 offset:20480
  ds_add_rtn_u32 v109, v117, v6 offset:20480
  ds_add_rtn_u32 v110, v118, v6 offset:20480
  ds_add_rtn_u32 v111, v119, v6 offset:20480
  s_waitcnt vmcnt(2) lgkmcnt(12)
  v_and_or_b32 v104, v28, s62, v104
  v_and_or_b32 v105, v29, s62, v105
  v_and_or_b32 v106, v30, s62, v106
  v_and_or_b32 v107, v31, s62, v107
  v_cmp_gt_u32 s[88:89], 32, v104
  v_cmp_gt_u32 s[90:91], 32, v105
  v_cmp_gt_u32 s[92:93], 32, v106
  v_cmp_gt_u32 s[94:95], 32, v107
  v_lshlrev_b32 v72, 2, v104
  v_lshlrev_b32 v73, 2, v105
  v_lshlrev_b32 v74, 2, v106
  v_lshlrev_b32 v75, 2, v107
  v_lshl_add_u32 v72, v112, 5, v72
  v_lshl_add_u32 v73, v113, 5, v73
  v_lshl_add_u32 v74, v114, 5, v74
  v_lshl_add_u32 v75, v115, 5, v75
  v_cndmask_b32 v72, v69, v72, s[88:89]
  v_cndmask_b32 v73, v69, v73, s[90:91]
  v_cndmask_b32 v74, v69, v74, s[92:93]
  v_cndmask_b32 v75, v69, v75, s[94:95]
  v_lshrrev_b32 v76, 1, v72
  v_lshrrev_b32 v77, 1, v73
  v_lshrrev_b32 v78, 1, v74
  v_lshrrev_b32 v79, 1, v75
  ds_write_b32 v72, v28 offset:47616
  ds_write_b32 v73, v29 offset:47616
  ds_write_b32 v74, v30 offset:47616
  ds_write_b32 v75, v31 offset:47616
  ds_write_b16 v76, v40 offset:22528
  ds_write_b16_d16_hi v77, v40 offset:22528
  ds_write_b16 v78, v41 offset:22528
  ds_write_b16_d16_hi v79, v41 offset:22528
  v_cmp_le_i32 s[88:89], 32, v104
  v_cmp_le_i32 s[90:91], 32, v105
  v_cmp_le_i32 s[92:93], 32, v106
  v_cmp_le_i32 s[94:95], 32, v107
  s_or_b64 s[88:89], s[88:89], s[90:91]
  s_or_b64 s[92:93], s[92:93], s[94:95]
  s_or_b64 s[54:55], s[54:55], s[88:89]
  s_or_b64 s[54:55], s[54:55], s[92:93]
  s_waitcnt vmcnt(0) lgkmcnt(8)
  v_and_or_b32 v108, v32, s62, v108
  v_and_or_b32 v109, v33, s62, v109
  v_and_or_b32 v110, v34, s62, v110
  v_and_or_b32 v111, v35, s62, v111
  v_cmp_gt_u32 s[88:89], 32, v108
  v_cmp_gt_u32 s[90:91], 32, v109
  v_cmp_gt_u32 s[92:93], 32, v110
  v_cmp_gt_u32 s[94:95], 32, v111
  v_lshlrev_b32 v72, 2, v108
  v_lshlrev_b32 v73, 2, v109
  v_lshlrev_b32 v74, 2, v110
  v_lshlrev_b32 v75, 2, v111
  v_lshl_add_u32 v72, v116, 5, v72
  v_lshl_add_u32 v73, v117, 5, v73
  v_lshl_add_u32 v74, v118, 5, v74
  v_lshl_add_u32 v75, v119, 5, v75
  v_cndmask_b32 v72, v69, v72, s[88:89]
  v_cndmask_b32 v73, v69, v73, s[90:91]
  v_cndmask_b32 v74, v69, v74, s[92:93]
  v_cndmask_b32 v75, v69, v75, s[94:95]
  v_lshrrev_b32 v76, 1, v72
  v_lshrrev_b32 v77, 1, v73
  v_lshrrev_b32 v78, 1, v74
  v_lshrrev_b32 v79, 1, v75
  ds_write_b32 v72, v32 offset:47616
  ds_write_b32 v73, v33 offset:47616
  ds_write_b32 v74, v34 offset:47616
  ds_write_b32 v75, v35 offset:47616
  ds_write_b16 v76, v42 offset:22528
  ds_write_b16_d16_hi v77, v42 offset:22528
  ds_write_b16 v78, v43 offset:22528
  ds_write_b16_d16_hi v79, v43 offset:22528
  v_cmp_le_i32 s[88:89], 32, v108
  v_cmp_le_i32 s[90:91], 32, v109
  v_cmp_le_i32 s[92:93], 32, v110
  v_cmp_le_i32 s[94:95], 32, v111
  s_or_b64 s[88:89], s[88:89], s[90:91]
  s_or_b64 s[92:93], s[92:93], s[94:95]
  s_or_b64 s[54:55], s[54:55], s[88:89]
  s_or_b64 s[54:55], s[54:55], s[92:93]
  v_min_u32 v70, 64, v44
  v_sub_u32 v44, v44, v70
  v_add_u32 v48, 256, v48
  v_min_u32 v70, 64, v45
  v_sub_u32 v45, v45, v70
  v_add_u32 v49, 256, v49
  v_min_u32 v70, 64, v46
  v_sub_u32 v46, v46, v70
  v_add_u32 v50, 256, v50
  v_min_u32 v70, 64, v47
  v_sub_u32 v47, v47, v70
  v_add_u32 v51, 256, v51
  v_or_b32 v70, v44, v45
  v_or3_b32 v70, v70, v46, v47
  v_cmp_lt_u32 vcc, 0, v70
  s_nop 1
  s_cmp_lg_u64 vcc, 0
  s_cselect_b32 s3, 1, 0
  s_cbranch_scc1 L_bin_more
  s_waitcnt lgkmcnt(0)
  v_mov_b32 v70, 22524
  s_mov_b64 exec, 1
  ds_add_u32 v70, v6
  s_mov_b64 exec, -1
L_bin_more:
  s_cmp_eq_u64 s[54:55], 0
  s_cbranch_scc1 L_bin_noovf
  v_cmp_le_i32 s[88:89], 32, v96
  v_cmp_le_i32 s[90:91], 32, v97
  v_cmp_le_i32 s[92:93], 32, v98
  v_cmp_le_i32 s[94:95], 32, v99
  s_or_b64 s[54:55], s[88:89], s[90:91]
  s_or_b64 s[54:55], s[54:55], s[92:93]
  s_or_b64 s[54:55], s[54:55], s[94:95]
  s_cmp_eq_u64 s[54:55], 0
  s_cbranch_scc1 L_bin_ovf0
  v_cndmask_b32 v60, -1, v20, s[88:89]
  v_cndmask_b32 v61, -1, v21, s[90:91]
  v_cndmask_b32 v62, -1, v22, s[92:93]
  v_cndmask_b32 v63, -1, v23, s[94:95]
  v_and_b32 v70, 0x1fffff, v60
  v_ashrrev_i32 v60, 16, v60
  buffer_load_dwordx2 v[112:113], v70, s[12:15], 0 offen
  v_and_b32 v60, 0x8000ffe0, v60
  v_and_b32 v70, 0x1fffff, v61
  v_ashrrev_i32 v61, 16, v61
  buffer_load_dwordx2 v[114:115], v70, s[12:15], 0 offen
  v_and_b32 v61, 0x8000ffe0, v61
  v_and_b32 v70, 0x1fffff, v62
  v_ashrrev_i32 v62, 16, v62
  buffer_load_dwordx2 v[116:117], v70, s[12:15], 0 offen
  v_and_b32 v62, 0x8000ffe0, v62
  v_and_b32 v70, 0x1fffff, v63
  v_ashrrev_i32 v63, 16, v63
  buffer_load_dwordx2 v[118:119], v70, s[12:15], 0 offen
  v_and_b32 v63, 0x8000ffe0, v63
  s_waitcnt vmcnt(0)
  v_lshlrev_b32 v71, 16, v36
  v_mov_b32_dpp v72, v112 quad_perm:[0,0,0,0] row_mask:0xf bank_mask:0xf
  v_mov_b32_dpp v73, v112 quad_perm:[1,1,1,1] row_mask:0xf bank_mask:0xf
  v_mov_b32_dpp v74, v112 quad_perm:[2,2,2,2] row_mask:0xf bank_mask:0xf
  v_mov_b32_dpp v75, v112 quad_perm:[3,3,3,3] row_mask:0xf bank_mask:0xf
  v_mov_b32_dpp v88, v113 quad_perm:[0,0,0,0] row_mask:0xf bank_mask:0xf
  v_mov_b32_dpp v89, v113 quad_perm:[1,1,1,1] row_mask:0xf bank_mask:0xf
  v_mov_b32_dpp v90, v113 quad_perm:[2,2,2,2] row_mask:0xf bank_mask:0xf
  v_mov_b32_dpp v91, v113 quad_perm:[3,3,3,3] row_mask:0xf bank_mask:0xf
  v_perm_b32 v88, v88, v72, v68
  v_perm_b32 v89, v89, v73, v68
  v_perm_b32 v90, v90, v74, v68
  v_perm_b32 v91, v91, v75, v68
  v_add_u32_dpp v84, v60, v5 quad_perm:[0,0,0,0] row_mask:0xf bank_mask:0xf
  v_add_u32_dpp v85, v60, v5 quad_perm:[1,1,1,1] row_mask:0xf bank_mask:0xf
  v_add_u32_dpp v86, v60, v5 quad_perm:[2,2,2,2] row_mask:0xf bank_mask:0xf
  v_add_u32_dpp v87, v60, v5 quad_perm:[3,3,3,3] row_mask:0xf bank_mask:0xf
  v_mul_f32_dpp v88, v71, v88 quad_perm:[0,0,0,0] row_mask:0xf bank_mask:0xf
  v_mul_f32_dpp v89, v71, v89 quad_perm:[1,1,1,1] row_mask:0xf bank_mask:0xf
  v_mul_f32_dpp v90, v71, v90 quad_perm:[2,2,2,2] row_mask:0xf bank_mask:0xf
  v_mul_f32_dpp v91, v71, v91 quad_perm:[3,3,3,3] row_mask:0xf bank_mask:0xf
  v_cvt_f64_f32 v[76:77], v88
  v_cvt_f64_f32 v[78:79], v89
  v_cvt_f64_f32 v[80:81], v90
  v_cvt_f64_f32 v[82:83], v91
  ds_add_f64 v84, v[76:77]
  ds_add_f64 v85, v[78:79]
  ds_add_f64 v86, v[80:81]
  ds_add_f64 v87, v[82:83]
  v_and_b32 v71, 0xffff0000, v36
  v_mov_b32_dpp v72, v114 quad_perm:[0,0,0,0] row_mask:0xf bank_mask:0xf
  v_mov_b32_dpp v73, v114 quad_perm:[1,1,1,1] row_mask:0xf bank_mask:0xf
  v_mov_b32_dpp v74, v114 quad_perm:[2,2,2,2] row_mask:0xf bank_mask:0xf
  v_mov_b32_dpp v75, v114 quad_perm:[3,3,3,3] row_mask:0xf bank_mask:0xf
  v_mov_b32_dpp v88, v115 quad_perm:[0,0,0,0] row_mask:0xf bank_mask:0xf
  v_mov_b32_dpp v89, v115 quad_perm:[1,1,1,1] row_mask:0xf bank_mask:0xf
  v_mov_b32_dpp v90, v115 quad_perm:[2,2,2,2] row_mask:0xf bank_mask:0xf
  v_mov_b32_dpp v91, v115 quad_perm:[3,3,3,3] row_mask:0xf bank_mask:0xf
  v_perm_b32 v88, v88, v72, v68
  v_perm_b32 v89, v89, v73, v68
  v_perm_b32 v90, v90, v74, v68
  v_perm_b32 v91, v91, v75, v68
  v_add_u32_dpp v84, v61, v5 quad_perm:[0,0,0,0] row_mask:0xf bank_mask:0xf
  v_add_u32_dpp v85, v61, v5 quad_perm:[1,1,1,1] row_mask:0xf bank_mask:0xf
  v_add_u32_dpp v86, v61, v5 quad_perm:[2,2,2,2] row_mask:0xf bank_mask:0xf
  v_add_u32_dpp v87, v61, v5 quad_perm:[3,3,3,3] row_mask:0xf bank_mask:0xf
  v_mul_f32_dpp v88, v71, v88 quad_perm:[0,0,0,0] row_mask:0xf bank_mask:0xf
  v_mul_f32_dpp v89, v71, v89 quad_perm:[1,1,1,1] row_mask:0xf bank_mask:0xf
  v_mul_f32_dpp v90, v71, v90 quad_perm:[2,2,2,2] row_mask:0xf bank_mask:0xf
  v_mul_f32_dpp v91, v71, v91 quad_perm:[3,3,3,3] row_mask:0xf bank_mask:0xf
  v_cvt_f64_f32 v[76:77], v88
  v_cvt_f64_f32 v[78:79], v89
  v_cvt_f64_f32 v[80:81], v90
  v_cvt_f64_f32 v[82:83], v91
  ds_add_f64 v84, v[76:77]
  ds_add_f64 v85, v[78:79]
  ds_add_f64 v86, v[80:81]
  ds_add_f64 v87, v[82:83]
  v_lshlrev_b32 v71, 16, v37
  v_mov_b32_dpp v72, v116 quad_perm:[0,0,0,0] row_mask:0xf bank_mask:0xf
  v_mov_b32_dpp v73, v116 quad_perm:[1,1,1,1] row_mask:0xf bank_mask:0xf
  v_mov_b32_dpp v74, v116 quad_perm:[2,2,2,2] row_mask:0xf bank_mask:0xf
  v_mov_b32_dpp v75, v116 quad_perm:[3,3,3,3] row_mask:0xf bank_mask:0xf
  v_mov_b32_dpp v88, v117 quad_perm:[0,0,0,0] row_mask:0xf bank_mask:0xf
  v_mov_b32_dpp v89, v117 quad_perm:[1,1,1,1] row_mask:0xf bank_mask:0xf
  v_mov_b32_dpp v90, v117 quad_perm:[2,2,2,2] row_mask:0xf bank_mask:0xf
  v_mov_b32_dpp v91, v117 quad_perm:[3,3,3,3] row_mask:0xf bank_mask:0xf
  v_perm_b32 v88, v88, v72, v68
  v_perm_b32 v89, v89, v73, v68
  v_perm_b32 v90, v90, v74, v68
  v_perm_b32 v91, v91, v75, v68
  v_add_u32_dpp v84, v62, v5 quad_perm:[0,0,0,0] row_mask:0xf bank_mask:0xf
  v_add_u32_dpp v85, v62, v5 quad_perm:[1,1,1,1] row_mask:0xf bank_mask:0xf
  v_add_u32_dpp v86, v62, v5 quad_perm:[2,2,2,2] row_mask:0xf bank_mask:0xf
  v_add_u32_dpp v87, v62, v5 quad_perm:[3,3,3,3] row_mask:0xf bank_mask:0xf
  v_mul_f32_dpp v88, v71, v88 quad_perm:[0,0,0,0] row_mask:0xf bank_mask:0xf
  v_mul_f32_dpp v89, v71, v89 quad_perm:[1,1,1,1] row_mask:0xf bank_mask:0xf
  v_mul_f32_dpp v90, v71, v90 quad_perm:[2,2,2,2] row_mask:0xf bank_mask:0xf
  v_mul_f32_dpp v91, v71, v91 quad_perm:[3,3,3,3] row_mask:0xf bank_mask:0xf
  v_cvt_f64_f32 v[76:77], v88
  v_cvt_f64_f32 v[78:79], v89
  v_cvt_f64_f32 v[80:81], v90
  v_cvt_f64_f32 v[82:83], v91
  ds_add_f64 v84, v[76:77]
  ds_add_f64 v85, v[78:79]
  ds_add_f64 v86, v[80:81]
  ds_add_f64 v87, v[82:83]
  v_and_b32 v71, 0xffff0000, v37
  v_mov_b32_dpp v72, v118 quad_perm:[0,0,0,0] row_mask:0xf bank_mask:0xf
  v_mov_b32_dpp v73, v118 quad_perm:[1,1,1,1] row_mask:0xf bank_mask:0xf
  v_mov_b32_dpp v74, v118 quad_perm:[2,2,2,2] row_mask:0xf bank_mask:0xf
  v_mov_b32_dpp v75, v118 quad_perm:[3,3,3,3] row_mask:0xf bank_mask:0xf
  v_mov_b32_dpp v88, v119 quad_perm:[0,0,0,0] row_mask:0xf bank_mask:0xf
  v_mov_b32_dpp v89, v119 quad_perm:[1,1,1,1] row_mask:0xf bank_mask:0xf
  v_mov_b32_dpp v90, v119 quad_perm:[2,2,2,2] row_mask:0xf bank_mask:0xf
  v_mov_b32_dpp v91, v119 quad_perm:[3,3,3,3] row_mask:0xf bank_mask:0xf
  v_perm_b32 v88, v88, v72, v68
  v_perm_b32 v89, v89, v73, v68
  v_perm_b32 v90, v90, v74, v68
  v_perm_b32 v91, v91, v75, v68
  v_add_u32_dpp v84, v63, v5 quad_perm:[0,0,0,0] row_mask:0xf bank_mask:0xf
  v_add_u32_dpp v85, v63, v5 quad_perm:[1,1,1,1] row_mask:0xf bank_mask:0xf
  v_add_u32_dpp v86, v63, v5 quad_perm:[2,2,2,2] row_mask:0xf bank_mask:0xf
  v_add_u32_dpp v87, v63, v5 quad_perm:[3,3,3,3] row_mask:0xf bank_mask:0xf
  v_mul_f32_dpp v88, v71, v88 quad_perm:[0,0,0,0] row_mask:0xf bank_mask:0xf
  v_mul_f32_dpp v89, v71, v89 quad_perm:[1,1,1,1] row_mask:0xf bank_mask:0xf
  v_mul_f32_dpp v90, v71, v90 quad_perm:[2,2,2,2] row_mask:0xf bank_mask:0xf
  v_mul_f32_dpp v91, v71, v91 quad_perm:[3,3,3,3] row_mask:0xf bank_mask:0xf
  v_cvt_f64_f32 v[76:77], v88
  v_cvt_f64_f32 v[78:79], v89
  v_cvt_f64_f32 v[80:81], v90
  v_cvt_f64_f32 v[82:83], v91
  ds_add_f64 v84, v[76:77]
  ds_add_f64 v85, v[78:79]
  ds_add_f64 v86, v[80:81]
  ds_add_f64 v87, v[82:83]
L_bin_ovf0:
  v_cmp_le_i32 s[88:89], 32, v100
  v_cmp_le_i32 s[90:91], 32, v101
  v_cmp_le_i32 s[92:93], 32, v102
  v_cmp_le_i32 s[94:95], 32, v103
  s_or_b64 s[54:55], s[88:89], s[90:91]
  s_or_b64 s[54:55], s[54:55], s[92:93]
  s_or_b64 s[54:55], s[54:55], s[94:95]
  s_cmp_eq_u64 s[54:55], 0
  s_cbranch_scc1 L_bin_ovf1
  v_cndmask_b32 v60, -1, v24, s[88:89]
  v_cndmask_b32 v61, -1, v25, s[90:91]
  v_cndmask_b32 v62, -1, v26, s[92:93]
  v_cndmask_b32 v63, -1, v27, s[94:95]
  v_and_b32 v70, 0x1fffff, v60
  v_ashrrev_i32 v60, 16, v60
  buffer_load_dwordx2 v[112:113], v70, s[12:15], 0 offen
  v_and_b32 v60, 0x8000ffe0, v60
  v_and_b32 v70, 0x1fffff, v61
  v_ashrrev_i32 v61, 16, v61
  buffer_load_dwordx2 v[114:115], v70, s[12:15], 0 offen
  v_and_b32 v61, 0x8000ffe0, v61
  v_and_b32 v70, 0x1fffff, v62
  v_ashrrev_i32 v62, 16, v62
  buffer_load_dwordx2 v[116:117], v70, s[12:15], 0 offen
  v_and_b32 v62, 0x8000ffe0, v62
  v_and_b32 v70, 0x1fffff, v63
  v_ashrrev_i32 v63, 16, v63
  buffer_load_dwordx2 v[118:119], v70, s[12:15], 0 offen
  v_and_b32 v63, 0x8000ffe0, v63
  s_waitcnt vmcnt(0)
  v_lshlrev_b32 v71, 16, v38
  v_mov_b32_dpp v72, v112 quad_perm:[0,0,0,0] row_mask:0xf bank_mask:0xf
  v_mov_b32_dpp v73, v112 quad_perm:[1,1,1,1] row_mask:0xf bank_mask:0xf
  v_mov_b32_dpp v74, v112 quad_perm:[2,2,2,2] row_mask:0xf bank_mask:0xf
  v_mov_b32_dpp v75, v112 quad_perm:[3,3,3,3] row_mask:0xf bank_mask:0xf
  v_mov_b32_dpp v88, v113 quad_perm:[0,0,0,0] row_mask:0xf bank_mask:0xf
  v_mov_b32_dpp v89, v113 quad_perm:[1,1,1,1] row_mask:0xf bank_mask:0xf
  v_mov_b32_dpp v90, v113 quad_perm:[2,2,2,2] row_mask:0xf bank_mask:0xf
  v_mov_b32_dpp v91, v113 quad_perm:[3,3,3,3] row_mask:0xf bank_mask:0xf
  v_perm_b32 v88, v88, v72, v68
  v_perm_b32 v89, v89, v73, v68
  v_perm_b32 v90, v90, v74, v68
  v_perm_b32 v91, v91, v75, v68
  v_add_u32_dpp v84, v60, v5 quad_perm:[0,0,0,0] row_mask:0xf bank_mask:0xf
  v_add_u32_dpp v85, v60, v5 quad_perm:[1,1,1,1] row_mask:0xf bank_mask:0xf
  v_add_u32_dpp v86, v60, v5 quad_perm:[2,2,2,2] row_mask:0xf bank_mask:0xf
  v_add_u32_dpp v87, v60, v5 quad_perm:[3,3,3,3] row_mask:0xf bank_mask:0xf
  v_mul_f32_dpp v88, v71, v88 quad_perm:[0,0,0,0] row_mask:0xf bank_mask:0xf
  v_mul_f32_dpp v89, v71, v89 quad_perm:[1,1,1,1] row_mask:0xf bank_mask:0xf
  v_mul_f32_dpp v90, v71, v90 quad_perm:[2,2,2,2] row_mask:0xf bank_mask:0xf
  v_mul_f32_dpp v91, v71, v91 quad_perm:[3,3,3,3] row_mask:0xf bank_mask:0xf
  v_cvt_f64_f32 v[76:77], v88
  v_cvt_f64_f32 v[78:79], v89
  v_cvt_f64_f32 v[80:81], v90
  v_cvt_f64_f32 v[82:83], v91
  ds_add_f64 v84, v[76:77]
  ds_add_f64 v85, v[78:79]
  ds_add_f64 v86, v[80:81]
  ds_add_f64 v87, v[82:83]
  v_and_b32 v71, 0xffff0000, v38
  v_mov_b32_dpp v72, v114 quad_perm:[0,0,0,0] row_mask:0xf bank_mask:0xf
  v_mov_b32_dpp v73, v114 quad_perm:[1,1,1,1] row_mask:0xf bank_mask:0xf
  v_mov_b32_dpp v74, v114 quad_perm:[2,2,2,2] row_mask:0xf bank_mask:0xf
  v_mov_b32_dpp v75, v114 quad_perm:[3,3,3,3] row_mask:0xf bank_mask:0xf
  v_mov_b32_dpp v88, v115 quad_perm:[0,0,0,0] row_mask:0xf bank_mask:0xf
  v_mov_b32_dpp v89, v115 quad_perm:[1,1,1,1] row_mask:0xf bank_mask:0xf
  v_mov_b32_dpp v90, v115 quad_perm:[2,2,2,2] row_mask:0xf bank_mask:0xf
  v_mov_b32_dpp v91, v115 quad_perm:[3,3,3,3] row_mask:0xf bank_mask:0xf
  v_perm_b32 v88, v88, v72, v68
  v_perm_b32 v89, v89, v73, v68
  v_perm_b32 v90, v90, v74, v68
  v_perm_b32 v91, v91, v75, v68
  v_add_u32_dpp v84, v61, v5 quad_perm:[0,0,0,0] row_mask:0xf bank_mask:0xf
  v_add_u32_dpp v85, v61, v5 quad_perm:[1,1,1,1] row_mask:0xf bank_mask:0xf
  v_add_u32_dpp v86, v61, v5 quad_perm:[2,2,2,2] row_mask:0xf bank_mask:0xf
  v_add_u32_dpp v87, v61, v5 quad_perm:[3,3,3,3] row_mask:0xf bank_mask:0xf
  v_mul_f32_dpp v88, v71, v88 quad_perm:[0,0,0,0] row_mask:0xf bank_mask:0xf
  v_mul_f32_dpp v89, v71, v89 quad_perm:[1,1,1,1] row_mask:0xf bank_mask:0xf
  v_mul_f32_dpp v90, v71, v90 quad_perm:[2,2,2,2] row_mask:0xf bank_mask:0xf
  v_mul_f32_dpp v91, v71, v91 quad_perm:[3,3,3,3] row_mask:0xf bank_mask:0xf
  v_cvt_f64_f32 v[76:77], v88
  v_cvt_f64_f32 v[78:79], v89
  v_cvt_f64_f32 v[80:81], v90
  v_cvt_f64_f32 v[82:83], v91
  ds_add_f64 v84, v[76:77]
  ds_add_f64 v85, v[78:79]
  ds_add_f64 v86, v[80:81]
  ds_add_f64 v87, v[82:83]
  v_lshlrev_b32 v71, 16, v39
  v_mov_b32_dpp v72, v116 quad_perm:[0,0,0,0] row_mask:0xf bank_mask:0xf
  v_mov_b32_dpp v73, v116 quad_perm:[1,1,1,1] row_mask:0xf bank_mask:0xf
  v_mov_b32_dpp v74, v116 quad_perm:[2,2,2,2] row_mask:0xf bank_mask:0xf
  v_mov_b32_dpp v75, v116 quad_perm:[3,3,3,3] row_mask:0xf bank_mask:0xf
  v_mov_b32_dpp v88, v117 quad_perm:[0,0,0,0] row_mask:0xf bank_mask:0xf
  v_mov_b32_dpp v89, v117 quad_perm:[1,1,1,1] row_mask:0xf bank_mask:0xf
  v_mov_b32_dpp v90, v117 quad_perm:[2,2,2,2] row_mask:0xf bank_mask:0xf
  v_mov_b32_dpp v91, v117 quad_perm:[3,3,3,3] row_mask:0xf bank_mask:0xf
  v_perm_b32 v88, v88, v72, v68
  v_perm_b32 v89, v89, v73, v68
  v_perm_b32 v90, v90, v74, v68
  v_perm_b32 v91, v91, v75, v68
  v_add_u32_dpp v84, v62, v5 quad_perm:[0,0,0,0] row_mask:0xf bank_mask:0xf
  v_add_u32_dpp v85, v62, v5 quad_perm:[1,1,1,1] row_mask:0xf bank_mask:0xf
  v_add_u32_dpp v86, v62, v5 quad_perm:[2,2,2,2] row_mask:0xf bank_mask:0xf
  v_add_u32_dpp v87, v62, v5 quad_perm:[3,3,3,3] row_mask:0xf bank_mask:0xf
  v_mul_f32_dpp v88, v71, v88 quad_perm:[0,0,0,0] row_mask:0xf bank_mask:0xf
  v_mul_f32_dpp v89, v71, v89 quad_perm:[1,1,1,1] row_mask:0xf bank_mask:0xf
  v_mul_f32_dpp v90, v71, v90 quad_perm:[2,2,2,2] row_mask:0xf bank_mask:0xf
  v_mul_f32_dpp v91, v71, v91 quad_perm:[3,3,3,3] row_mask:0xf bank_mask:0xf
  v_cvt_f64_f32 v[76:77], v88
  v_cvt_f64_f32 v[78:79], v89
  v_cvt_f64_f32 v[80:81], v90
  v_cvt_f64_f32 v[82:83], v91
  ds_add_f64 v84, v[76:77]
  ds_add_f64 v85, v[78:79]
  ds_add_f64 v86, v[80:81]
  ds_add_f64 v87, v[82:83]
  v_and_b32 v71, 0xffff0000, v39
  v_mov_b32_dpp v72, v118 quad_perm:[0,0,0,0] row_mask:0xf bank_mask:0xf
  v_mov_b32_dpp v73, v118 quad_perm:[1,1,1,1] row_mask:0xf bank_mask:0xf
  v_mov_b32_dpp v74, v118 quad_perm:[2,2,2,2] row_mask:0xf bank_mask:0xf
  v_mov_b32_dpp v75, v118 quad_perm:[3,3,3,3] row_mask:0xf bank_mask:0xf
  v_mov_b32_dpp v88, v119 quad_perm:[0,0,0,0] row_mask:0xf bank_mask:0xf
  v_mov_b32_dpp v89, v119 quad_perm:[1,1,1,1] row_mask:0xf bank_mask:0xf
  v_mov_b32_dpp v90, v119 quad_perm:[2,2,2,2] row_mask:0xf bank_mask:0xf
  v_mov_b32_dpp v91, v119 quad_perm:[3,3,3,3] row_mask:0xf bank_mask:0xf
  v_perm_b32 v88, v88, v72, v68
  v_perm_b32 v89, v89, v73, v68
  v_perm_b32 v90, v90, v74, v68
  v_perm_b32 v91, v91, v75, v68
  v_add_u32_dpp v84, v63, v5 quad_perm:[0,0,0,0] row_mask:0xf bank_mask:0xf
  v_add_u32_dpp v85, v63, v5 quad_perm:[1,1,1,1] row_mask:0xf bank_mask:0xf
  v_add_u32_dpp v86, v63, v5 quad_perm:[2,2,2,2] row_mask:0xf bank_mask:0xf
  v_add_u32_dpp v87, v63, v5 quad_perm:[3,3,3,3] row_mask:0xf bank_mask:0xf
  v_mul_f32_dpp v88, v71, v88 quad_perm:[0,0,0,0] row_mask:0xf bank_mask:0xf
  v_mul_f32_dpp v89, v71, v89 quad_perm:[1,1,1,1] row_mask:0xf bank_mask:0xf
  v_mul_f32_dpp v90, v71, v90 quad_perm:[2,2,2,2] row_mask:0xf bank_mask:0xf
  v_mul_f32_dpp v91, v71, v91 quad_perm:[3,3,3,3] row_mask:0xf bank_mask:0xf
  v_cvt_f64_f32 v[76:77], v88
  v_cvt_f64_f32 v[78:79], v89
  v_cvt_f64_f32 v[80:81], v90
  v_cvt_f64_f32 v[82:83], v91
  ds_add_f64 v84, v[76:77]
  ds_add_f64 v85, v[78:79]
  ds_add_f64 v86, v[80:81]
  ds_add_f64 v87, v[82:83]
L_bin_ovf1:
  v_cmp_le_i32 s[88:89], 32, v104
  v_cmp_le_i32 s[90:91], 32, v105
  v_cmp_le_i32 s[92:93], 32, v106
  v_cmp_le_i32 s[94:95], 32, v107
  s_or_b64 s[54:55], s[88:89], s[90:91]
  s_or_b64 s[54:55], s[54:55], s[92:93]
  s_or_b64 s[54:55], s[54:55], s[94:95]
  s_cmp_eq_u64 s[54:55], 0
  s_cbranch_scc1 L_bin_ovf2
  v_cndmask_b32 v60, -1, v28, s[88:89]
  v_cndmask_b32 v61, -1, v29, s[90:91]
  v_cndmask_b32 v62, -1, v30, s[92:93]
  v_cndmask_b32 v63, -1, v31, s[94:95]
  v_and_b32 v70, 0x1fffff, v60
  v_ashrrev_i32 v60, 16, v60
  buffer_load_dwordx2 v[112:113], v70, s[12:15], 0 offen
  v_and_b32 v60, 0x8000ffe0, v60
  v_and_b32 v70, 0x1fffff, v61
  v_ashrrev_i32 v61, 16, v61
  buffer_load_dwordx2 v[114:115], v70, s[12:15], 0 offen
  v_and_b32 v61, 0x8000ffe0, v61
  v_and_b32 v70, 0x1fffff, v62
  v_ashrrev_i32 v62, 16, v62
  buffer_load_dwordx2 v[116:117], v70, s[12:15], 0 offen
  v_and_b32 v62, 0x8000ffe0, v62
  v_and_b32 v70, 0x1fffff, v63
  v_ashrrev_i32 v63, 16, v63
  buffer_load_dwordx2 v[118:119], v70, s[12:15], 0 offen
  v_and_b32 v63, 0x8000ffe0, v63
  s_waitcnt vmcnt(0)
  v_lshlrev_b32 v71, 16, v40
  v_mov_b32_dpp v72, v112 quad_perm:[0,0,0,0] row_mask:0xf bank_mask:0xf
  v_mov_b32_dpp v73, v112 quad_perm:[1,1,1,1] row_mask:0xf bank_mask:0xf
  v_mov_b32_dpp v74, v112 quad_perm:[2,2,2,2] row_mask:0xf bank_mask:0xf
  v_mov_b32_dpp v75, v112 quad_perm:[3,3,3,3] row_mask:0xf bank_mask:0xf
  v_mov_b32_dpp v88, v113 quad_perm:[0,0,0,0] row_mask:0xf bank_mask:0xf
  v_mov_b32_dpp v89, v113 quad_perm:[1,1,1,1] row_mask:0xf bank_mask:0xf
  v_mov_b32_dpp v90, v113 quad_perm:[2,2,2,2] row_mask:0xf bank_mask:0xf
  v_mov_b32_dpp v91, v113 quad_perm:[3,3,3,3] row_mask:0xf bank_mask:0xf
  v_perm_b32 v88, v88, v72, v68
  v_perm_b32 v89, v89, v73, v68
  v_perm_b32 v90, v90, v74, v68
  v_perm_b32 v91, v91, v75, v68
  v_add_u32_dpp v84, v60, v5 quad_perm:[0,0,0,0] row_mask:0xf bank_mask:0xf
  v_add_u32_dpp v85, v60, v5 quad_perm:[1,1,1,1] row_mask:0xf bank_mask:0xf
  v_add_u32_dpp v86, v60, v5 quad_perm:[2,2,2,2] row_mask:0xf bank_mask:0xf
  v_add_u32_dpp v87, v60, v5 quad_perm:[3,3,3,3] row_mask:0xf bank_mask:0xf
  v_mul_f32_dpp v88, v71, v88 quad_perm:[0,0,0,0] row_mask:0xf bank_mask:0xf
  v_mul_f32_dpp v89, v71, v89 quad_perm:[1,1,1,1] row_mask:0xf bank_mask:0xf
  v_mul_f32_dpp v90, v71, v90 quad_perm:[2,2,2,2] row_mask:0xf bank_mask:0xf
  v_mul_f32_dpp v91, v71, v91 quad_perm:[3,3,3,3] row_mask:0xf bank_mask:0xf
  v_cvt_f64_f32 v[76:77], v88
  v_cvt_f64_f32 v[78:79], v89
  v_cvt_f64_f32 v[80:81], v90
  v_cvt_f64_f32 v[82:83], v91
  ds_add_f64 v84, v[76:77]
  ds_add_f64 v85, v[78:79]
  ds_add_f64 v86, v[80:81]
  ds_add_f64 v87, v[82:83]
  v_and_b32 v71, 0xffff0000, v40
  v_mov_b32_dpp v72, v114 quad_perm:[0,0,0,0] row_mask:0xf bank_mask:0xf
  v_mov_b32_dpp v73, v114 quad_perm:[1,1,1,1] row_mask:0xf bank_mask:0xf
  v_mov_b32_dpp v74, v114 quad_perm:[2,2,2,2] row_mask:0xf bank_mask:0xf
  v_mov_b32_dpp v75, v114 quad_perm:[3,3,3,3] row_mask:0xf bank_mask:0xf
  v_mov_b32_dpp v88, v115 quad_perm:[0,0,0,0] row_mask:0xf bank_mask:0xf
  v_mov_b32_dpp v89, v115 quad_perm:[1,1,1,1] row_mask:0xf bank_mask:0xf
  v_mov_b32_dpp v90, v115 quad_perm:[2,2,2,2] row_mask:0xf bank_mask:0xf
  v_mov_b32_dpp v91, v115 quad_perm:[3,3,3,3] row_mask:0xf bank_mask:0xf
  v_perm_b32 v88, v88, v72, v68
  v_perm_b32 v89, v89, v73, v68
  v_perm_b32 v90, v90, v74, v68
  v_perm_b32 v91, v91, v75, v68
  v_add_u32_dpp v84, v61, v5 quad_perm:[0,0,0,0] row_mask:0xf bank_mask:0xf
  v_add_u32_dpp v85, v61, v5 quad_perm:[1,1,1,1] row_mask:0xf bank_mask:0xf
  v_add_u32_dpp v86, v61, v5 quad_perm:[2,2,2,2] row_mask:0xf bank_mask:0xf
  v_add_u32_dpp v87, v61, v5 quad_perm:[3,3,3,3] row_mask:0xf bank_mask:0xf
  v_mul_f32_dpp v88, v71, v88 quad_perm:[0,0,0,0] row_mask:0xf bank_mask:0xf
  v_mul_f32_dpp v89, v71, v89 quad_perm:[1,1,1,1] row_mask:0xf bank_mask:0xf
  v_mul_f32_dpp v90, v71, v90 quad_perm:[2,2,2,2] row_mask:0xf bank_mask:0xf
  v_mul_f32_dpp v91, v71, v91 quad_perm:[3,3,3,3] row_mask:0xf bank_mask:0xf
  v_cvt_f64_f32 v[76:77], v88
  v_cvt_f64_f32 v[78:79], v89
  v_cvt_f64_f32 v[80:81], v90
  v_cvt_f64_f32 v[82:83], v91
  ds_add_f64 v84, v[76:77]
  ds_add_f64 v85, v[78:79]
  ds_add_f64 v86, v[80:81]
  ds_add_f64 v87, v[82:83]
  v_lshlrev_b32 v71, 16, v41
  v_mov_b32_dpp v72, v116 quad_perm:[0,0,0,0] row_mask:0xf bank_mask:0xf
  v_mov_b32_dpp v73, v116 quad_perm:[1,1,1,1] row_mask:0xf bank_mask:0xf
  v_mov_b32_dpp v74, v116 quad_perm:[2,2,2,2] row_mask:0xf bank_mask:0xf
  v_mov_b32_dpp v75, v116 quad_perm:[3,3,3,3] row_mask:0xf bank_mask:0xf
  v_mov_b32_dpp v88, v117 quad_perm:[0,0,0,0] row_mask:0xf bank_mask:0xf
  v_mov_b32_dpp v89, v117 quad_perm:[1,1,1,1] row_mask:0xf bank_mask:0xf
  v_mov_b32_dpp v90, v117 quad_perm:[2,2,2,2] row_mask:0xf bank_mask:0xf
  v_mov_b32_dpp v91, v117 quad_perm:[3,3,3,3] row_mask:0xf bank_mask:0xf
  v_perm_b32 v88, v88, v72, v68
  v_perm_b32 v89, v89, v73, v68
  v_perm_b32 v90, v90, v74, v68
  v_perm_b32 v91, v91, v75, v68
  v_add_u32_dpp v84, v62, v5 quad_perm:[0,0,0,0] row_mask:0xf bank_mask:0xf
  v_add_u32_dpp v85, v62, v5 quad_perm:[1,1,1,1] row_mask:0xf bank_mask:0xf
  v_add_u32_dpp v86, v62, v5 quad_perm:[2,2,2,2] row_mask:0xf bank_mask:0xf
  v_add_u32_dpp v87, v62, v5 quad_perm:[3,3,3,3] row_mask:0xf bank_mask:0xf
  v_mul_f32_dpp v88, v71, v88 quad_perm:[0,0,0,0] row_mask:0xf bank_mask:0xf
  v_mul_f32_dpp v89, v71, v89 quad_perm:[1,1,1,1] row_mask:0xf bank_mask:0xf
  v_mul_f32_dpp v90, v71, v90 quad_perm:[2,2,2,2] row_mask:0xf bank_mask:0xf
  v_mul_f32_dpp v91, v71, v91 quad_perm:[3,3,3,3] row_mask:0xf bank_mask:0xf
  v_cvt_f64_f32 v[76:77], v88
  v_cvt_f64_f32 v[78:79], v89
  v_cvt_f64_f32 v[80:81], v90
  v_cvt_f64_f32 v[82:83], v91
  ds_add_f64 v84, v[76:77]
  ds_add_f64 v85, v[78:79]
  ds_add_f64 v86, v[80:81]
  ds_add_f64 v87, v[82:83]
  v_and_b32 v71, 0xffff0000, v41
  v_mov_b32_dpp v72, v118 quad_perm:[0,0,0,0] row_mask:0xf bank_mask:0xf
  v_mov_b32_dpp v73, v118 quad_perm:[1,1,1,1] row_mask:0xf bank_mask:0xf
  v_mov_b32_dpp v74, v118 quad_perm:[2,2,2,2] row_mask:0xf bank_mask:0xf
  v_mov_b32_dpp v75, v118 quad_perm:[3,3,3,3] row_mask:0xf bank_mask:0xf
  v_mov_b32_dpp v88, v119 quad_perm:[0,0,0,0] row_mask:0xf bank_mask:0xf
  v_mov_b32_dpp v89, v119 quad_perm:[1,1,1,1] row_mask:0xf bank_mask:0xf
  v_mov_b32_dpp v90, v119 quad_perm:[2,2,2,2] row_mask:0xf bank_mask:0xf
  v_mov_b32_dpp v91, v119 quad_perm:[3,3,3,3] row_mask:0xf bank_mask:0xf
  v_perm_b32 v88, v88, v72, v68
  v_perm_b32 v89, v89, v73, v68
  v_perm_b32 v90, v90, v74, v68
  v_perm_b32 v91, v91, v75, v68
  v_add_u32_dpp v84, v63, v5 quad_perm:[0,0,0,0] row_mask:0xf bank_mask:0xf
  v_add_u32_dpp v85, v63, v5 quad_perm:[1,1,1,1] row_mask:0xf bank_mask:0xf
  v_add_u32_dpp v86, v63, v5 quad_perm:[2,2,2,2] row_mask:0xf bank_mask:0xf
  v_add_u32_dpp v87, v63, v5 quad_perm:[3,3,3,3] row_mask:0xf bank_mask:0xf
  v_mul_f32_dpp v88, v71, v88 quad_perm:[0,0,0,0] row_mask:0xf bank_mask:0xf
  v_mul_f32_dpp v89, v71, v89 quad_perm:[1,1,1,1] row_mask:0xf bank_mask:0xf
  v_mul_f32_dpp v90, v71, v90 quad_perm:[2,2,2,2] row_mask:0xf bank_mask:0xf
  v_mul_f32_dpp v91, v71, v91 quad_perm:[3,3,3,3] row_mask:0xf bank_mask:0xf
  v_cvt_f64_f32 v[76:77], v88
  v_cvt_f64_f32 v[78:79], v89
  v_cvt_f64_f32 v[80:81], v90
  v_cvt_f64_f32 v[82:83], v91
  ds_add_f64 v84, v[76:77]
  ds_add_f64 v85, v[78:79]
  ds_add_f64 v86, v[80:81]
  ds_add_f64 v87, v[82:83]
L_bin_ovf2:
  v_cmp_le_i32 s[88:89], 32, v108
  v_cmp_le_i32 s[90:91], 32, v109
  v_cmp_le_i32 s[92:93], 32, v110
  v_cmp_le_i32 s[94:95], 32, v111
  s_or_b64 s[54:55], s[88:89], s[90:91]
  s_or_b64 s[54:55], s[54:55], s[92:93]
  s_or_b64 s[54:55], s[54:55], s[94:95]
  s_cmp_eq_u64 s[54:55], 0
  s_cbranch_scc1 L_bin_ovf3
  v_cndmask_b32 v60, -1, v32, s[88:89]
  v_cndmask_b32 v61, -1, v33, s[90:91]
  v_cndmask_b32 v62, -1, v34, s[92:93]
  v_cndmask_b32 v63, -1, v35, s[94:95]
  v_and_b32 v70, 0x1fffff, v60
  v_ashrrev_i32 v60, 16, v60
  buffer_load_dwordx2 v[112:113], v70, s[12:15], 0 offen
  v_and_b32 v60, 0x8000ffe0, v60
  v_and_b32 v70, 0x1fffff, v61
  v_ashrrev_i32 v61, 16, v61
  buffer_load_dwordx2 v[114:115], v70, s[12:15], 0 offen
  v_and_b32 v61, 0x8000ffe0, v61
  v_and_b32 v70, 0x1fffff, v62
  v_ashrrev_i32 v62, 16, v62
  buffer_load_dwordx2 v[116:117], v70, s[12:15], 0 offen
  v_and_b32 v62, 0x8000ffe0, v62
  v_and_b32 v70, 0x1fffff, v63
  v_ashrrev_i32 v63, 16, v63
  buffer_load_dwordx2 v[118:119], v70, s[12:15], 0 offen
  v_and_b32 v63, 0x8000ffe0, v63
  s_waitcnt vmcnt(0)
  v_lshlrev_b32 v71, 16, v42
  v_mov_b32_dpp v72, v112 quad_perm:[0,0,0,0] row_mask:0xf bank_mask:0xf
  v_mov_b32_dpp v73, v112 quad_perm:[1,1,1,1] row_mask:0xf bank_mask:0xf
  v_mov_b32_dpp v74, v112 quad_perm:[2,2,2,2] row_mask:0xf bank_mask:0xf
  v_mov_b32_dpp v75, v112 quad_perm:[3,3,3,3] row_mask:0xf bank_mask:0xf
  v_mov_b32_dpp v88, v113 quad_perm:[0,0,0,0] row_mask:0xf bank_mask:0xf
  v_mov_b32_dpp v89, v113 quad_perm:[1,1,1,1] row_mask:0xf bank_mask:0xf
  v_mov_b32_dpp v90, v113 quad_perm:[2,2,2,2] row_mask:0xf bank_mask:0xf
  v_mov_b32_dpp v91, v113 quad_perm:[3,3,3,3] row_mask:0xf bank_mask:0xf
  v_perm_b32 v88, v88, v72, v68
  v_perm_b32 v89, v89, v73, v68
  v_perm_b32 v90, v90, v74, v68
  v_perm_b32 v91, v91, v75, v68
  v_add_u32_dpp v84, v60, v5 quad_perm:[0,0,0,0] row_mask:0xf bank_mask:0xf
  v_add_u32_dpp v85, v60, v5 quad_perm:[1,1,1,1] row_mask:0xf bank_mask:0xf
  v_add_u32_dpp v86, v60, v5 quad_perm:[2,2,2,2] row_mask:0xf bank_mask:0xf
  v_add_u32_dpp v87, v60, v5 quad_perm:[3,3,3,3] row_mask:0xf bank_mask:0xf
  v_mul_f32_dpp v88, v71, v88 quad_perm:[0,0,0,0] row_mask:0xf bank_mask:0xf
  v_mul_f32_dpp v89, v71, v89 quad_perm:[1,1,1,1] row_mask:0xf bank_mask:0xf
  v_mul_f32_dpp v90, v71, v90 quad_perm:[2,2,2,2] row_mask:0xf bank_mask:0xf
  v_mul_f32_dpp v91, v71, v91 quad_perm:[3,3,3,3] row_mask:0xf bank_mask:0xf
  v_cvt_f64_f32 v[76:77], v88
  v_cvt_f64_f32 v[78:79], v89
  v_cvt_f64_f32 v[80:81], v90
  v_cvt_f64_f32 v[82:83], v91
  ds_add_f64 v84, v[76:77]
  ds_add_f64 v85, v[78:79]
  ds_add_f64 v86, v[80:81]
  ds_add_f64 v87, v[82:83]
  v_and_b32 v71, 0xffff0000, v42
  v_mov_b32_dpp v72, v114 quad_perm:[0,0,0,0] row_mask:0xf bank_mask:0xf
  v_mov_b32_dpp v73, v114 quad_perm:[1,1,1,1] row_mask:0xf bank_mask:0xf
  v_mov_b32_dpp v74, v114 quad_perm:[2,2,2,2] row_mask:0xf bank_mask:0xf
  v_mov_b32_dpp v75, v114 quad_perm:[3,3,3,3] row_mask:0xf bank_mask:0xf
  v_mov_b32_dpp v88, v115 quad_perm:[0,0,0,0] row_mask:0xf bank_mask:0xf
  v_mov_b32_dpp v89, v115 quad_perm:[1,1,1,1] row_mask:0xf bank_mask:0xf
  v_mov_b32_dpp v90, v115 quad_perm:[2,2,2,2] row_mask:0xf bank_mask:0xf
  v_mov_b32_dpp v91, v115 quad_perm:[3,3,3,3] row_mask:0xf bank_mask:0xf
  v_perm_b32 v88, v88, v72, v68
  v_perm_b32 v89, v89, v73, v68
  v_perm_b32 v90, v90, v74, v68
  v_perm_b32 v91, v91, v75, v68
  v_add_u32_dpp v84, v61, v5 quad_perm:[0,0,0,0] row_mask:0xf bank_mask:0xf
  v_add_u32_dpp v85, v61, v5 quad_perm:[1,1,1,1] row_mask:0xf bank_mask:0xf
  v_add_u32_dpp v86, v61, v5 quad_perm:[2,2,2,2] row_mask:0xf bank_mask:0xf
  v_add_u32_dpp v87, v61, v5 quad_perm:[3,3,3,3] row_mask:0xf bank_mask:0xf
  v_mul_f32_dpp v88, v71, v88 quad_perm:[0,0,0,0] row_mask:0xf bank_mask:0xf
  v_mul_f32_dpp v89, v71, v89 quad_perm:[1,1,1,1] row_mask:0xf bank_mask:0xf
  v_mul_f32_dpp v90, v71, v90 quad_perm:[2,2,2,2] row_mask:0xf bank_mask:0xf
  v_mul_f32_dpp v91, v71, v91 quad_perm:[3,3,3,3] row_mask:0xf bank_mask:0xf
  v_cvt_f64_f32 v[76:77], v88
  v_cvt_f64_f32 v[78:79], v89
  v_cvt_f64_f32 v[80:81], v90
  v_cvt_f64_f32 v[82:83], v91
  ds_add_f64 v84, v[76:77]
  ds_add_f64 v85, v[78:79]
  ds_add_f64 v86, v[80:81]
  ds_add_f64 v87, v[82:83]
  v_lshlrev_b32 v71, 16, v43
  v_mov_b32_dpp v72, v116 quad_perm:[0,0,0,0] row_mask:0xf bank_mask:0xf
  v_mov_b32_dpp v73, v116 quad_perm:[1,1,1,1] row_mask:0xf bank_mask:0xf
  v_mov_b32_dpp v74, v116 quad_perm:[2,2,2,2] row_mask:0xf bank_mask:0xf
  v_mov_b32_dpp v75, v116 quad_perm:[3,3,3,3] row_mask:0xf bank_mask:0xf
  v_mov_b32_dpp v88, v117 quad_perm:[0,0,0,0] row_mask:0xf bank_mask:0xf
  v_mov_b32_dpp v89, v117 quad_perm:[1,1,1,1] row_mask:0xf bank_mask:0xf
  v_mov_b32_dpp v90, v117 quad_perm:[2,2,2,2] row_mask:0xf bank_mask:0xf
  v_mov_b32_dpp v91, v117 quad_perm:[3,3,3,3] row_mask:0xf bank_mask:0xf
  v_perm_b32 v88, v88, v72, v68
  v_perm_b32 v89, v89, v73, v68
  v_perm_b32 v90, v90, v74, v68
  v_perm_b32 v91, v91, v75, v68
  v_add_u32_dpp v84, v62, v5 quad_perm:[0,0,0,0] row_mask:0xf bank_mask:0xf
  v_add_u32_dpp v85, v62, v5 quad_perm:[1,1,1,1] row_mask:0xf bank_mask:0xf
  v_add_u32_dpp v86, v62, v5 quad_perm:[2,2,2,2] row_mask:0xf bank_mask:0xf
  v_add_u32_dpp v87, v62, v5 quad_perm:[3,3,3,3] row_mask:0xf bank_mask:0xf
  v_mul_f32_dpp v88, v71, v88 quad_perm:[0,0,0,0] row_mask:0xf bank_mask:0xf
  v_mul_f32_dpp v89, v71, v89 quad_perm:[1,1,1,1] row_mask:0xf bank_mask:0xf
  v_mul_f32_dpp v90, v71, v90 quad_perm:[2,2,2,2] row_mask:0xf bank_mask:0xf
  v_mul_f32_dpp v91, v71, v91 quad_perm:[3,3,3,3] row_mask:0xf bank_mask:0xf
  v_cvt_f64_f32 v[76:77], v88
  v_cvt_f64_f32 v[78:79], v89
  v_cvt_f64_f32 v[80:81], v90
  v_cvt_f64_f32 v[82:83], v91
  ds_add_f64 v84, v[76:77]
  ds_add_f64 v85, v[78:79]
  ds_add_f64 v86, v[80:81]
  ds_add_f64 v87, v[82:83]
  v_and_b32 v71, 0xffff0000, v43
  v_mov_b32_dpp v72, v118 quad_perm:[0,0,0,0] row_mask:0xf bank_mask:0xf
  v_mov_b32_dpp v73, v118 quad_perm:[1,1,1,1] row_mask:0xf bank_mask:0xf
  v_mov_b32_dpp v74, v118 quad_perm:[2,2,2,2] row_mask:0xf bank_mask:0xf
  v_mov_b32_dpp v75, v118 quad_perm:[3,3,3,3] row_mask:0xf bank_mask:0xf
  v_mov_b32_dpp v88, v119 quad_perm:[0,0,0,0] row_mask:0xf bank_mask:0xf
  v_mov_b32_dpp v89, v119 quad_perm:[1,1,1,1] row_mask:0xf bank_mask:0xf
  v_mov_b32_dpp v90, v119 quad_perm:[2,2,2,2] row_mask:0xf bank_mask:0xf
  v_mov_b32_dpp v91, v119 quad_perm:[3,3,3,3] row_mask:0xf bank_mask:0xf
  v_perm_b32 v88, v88, v72, v68
  v_perm_b32 v89, v89, v73, v68
  v_perm_b32 v90, v90, v74, v68
  v_perm_b32 v91, v91, v75, v68
  v_add_u32_dpp v84, v63, v5 quad_perm:[0,0,0,0] row_mask:0xf bank_mask:0xf
  v_add_u32_dpp v85, v63, v5 quad_perm:[1,1,1,1] row_mask:0xf bank_mask:0xf
  v_add_u32_dpp v86, v63, v5 quad_perm:[2,2,2,2] row_mask:0xf bank_mask:0xf
  v_add_u32_dpp v87, v63, v5 quad_perm:[3,3,3,3] row_mask:0xf bank_mask:0xf
  v_mul_f32_dpp v88, v71, v88 quad_perm:[0,0,0,0] row_mask:0xf bank_mask:0xf
  v_mul_f32_dpp v89, v71, v89 quad_perm:[1,1,1,1] row_mask:0xf bank_mask:0xf
  v_mul_f32_dpp v90, v71, v90 quad_perm:[2,2,2,2] row_mask:0xf bank_mask:0xf
  v_mul_f32_dpp v91, v71, v91 quad_perm:[3,3,3,3] row_mask:0xf bank_mask:0xf
  v_cvt_f64_f32 v[76:77], v88
  v_cvt_f64_f32 v[78:79], v89
  v_cvt_f64_f32 v[80:81], v90
  v_cvt_f64_f32 v[82:83], v91
  ds_add_f64 v84, v[76:77]
  ds_add_f64 v85, v[78:79]
  ds_add_f64 v86, v[80:81]
  ds_add_f64 v87, v[82:83]
L_bin_ovf3:
L_bin_noovf:
  s_cmp_lg_u32 s3, 0
  s_cbranch_scc1 L_bin_round
  v_mov_b32 v70, 22524
L_spin_bin:
  ds_read_b32 v71, v70
  s_waitcnt lgkmcnt(0)
  v_readfirstlane_b32 s97, v71
  s_nop 0
  s_cmp_ge_u32 s97, 10
  s_cbranch_scc1 L_spun_bin
  s_sleep 1
  s_branch L_spin_bin
L_spun_bin:
  v_and_b32 v70, 31, v1
  v_and_b32 v71, 3, v70
  v_lshrrev_b32 v70, 2, v70
  v_lshl_add_u32 v70, v71, 3, v70
  v_lshrrev_b32 v71, 5, v1
  v_lshl_add_u32 v70, v71, 5, v70
  s_mul_i32 s97, s96, 1024
  s_add_i32 s97, s97, -6144
  v_add_u32 v70, s97, v70
  v_lshlrev_b32 v2, 2, v70
  v_add_u32 v2, 47616, v2
  v_lshlrev_b32 v3, 1, v70
  v_add_u32 v3, 22528, v3
  v_mov_b32 v30, 0
  v_mov_b32 v31, 0
  v_mov_b32 v32, 0
  v_mov_b32 v33, 0
  s_mov_b32 s54, 0x88888888
  s_mov_b32 s55, 0x88888888
  s_waitcnt lgkmcnt(0)
  ds_read_b32 v20, v2 offset:0
  ds_read_u16_d16_hi v30, v3 offset:0
  ds_read_b32 v21, v2 offset:256
  ds_read_u16_d16_hi v31, v3 offset:128
  ds_read_b32 v22, v2 offset:512
  ds_read_u16_d16_hi v32, v3 offset:256
  s_waitcnt lgkmcnt(5)
  v_and_b32 v70, 0x1fffff, v20
  v_ashrrev_i32 v20, 16, v20
  buffer_load_dwordx2 v[96:97], v70, s[12:15], 0 offen
  v_and_b32 v20, 0x8000ffe0, v20
  ds_read_b32 v23, v2 offset:768
  ds_read_u16_d16_hi v33, v3 offset:384
  s_waitcnt lgkmcnt(5)
  v_and_b32 v70, 0x1fffff, v21
  v_ashrrev_i32 v21, 16, v21
  buffer_load_dwordx2 v[98:99], v70, s[12:15], 0 offen
  v_and_b32 v21, 0x8000ffe0, v21
  s_waitcnt vmcnt(1)
  s_waitcnt lgkmcnt(6)
  v_mov_b32_dpp v72, v96 quad_perm:[0,0,0,0] row_mask:0xf bank_mask:0xf
  v_mov_b32_dpp v73, v96 quad_perm:[1,1,1,1] row_mask:0xf bank_mask:0xf
  v_mov_b32_dpp v74, v96 quad_perm:[2,2,2,2] row_mask:0xf bank_mask:0xf
  v_mov_b32_dpp v88, v97 quad_perm:[0,0,0,0] row_mask:0xf bank_mask:0xf
  v_mov_b32_dpp v89, v97 quad_perm:[1,1,1,1] row_mask:0xf bank_mask:0xf
  v_mov_b32_dpp v90, v97 quad_perm:[2,2,2,2] row_mask:0xf bank_mask:0xf
  v_perm_b32 v88, v88, v72, v68
  v_perm_b32 v89, v89, v73, v68
  v_perm_b32 v90, v90, v74, v68
  v_add_u32_dpp v84, v20, v5 quad_perm:[0,0,0,0] row_mask:0xf bank_mask:0xf
  v_add_u32_dpp v85, v20, v5 quad_perm:[1,1,1,1] row_mask:0xf bank_mask:0xf
  v_add_u32_dpp v86, v20, v5 quad_perm:[2,2,2,2] row_mask:0xf bank_mask:0xf
  v_mul_f32_dpp v88, v30, v88 quad_perm:[0,0,0,0] row_mask:0xf bank_mask:0xf
  v_mul_f32_dpp v89, v30, v89 quad_perm:[1,1,1,1] row_mask:0xf bank_mask:0xf
  v_mul_f32_dpp v90, v30, v90 quad_perm:[2,2,2,2] row_mask:0xf bank_mask:0xf
  v_cvt_f64_f32 v[76:77], v88
  v_cvt_f64_f32 v[78:79], v89
  v_cvt_f64_f32 v[80:81], v90
  ds_add_f64 v84, v[76:77]
  ds_add_f64 v85, v[78:79]
  ds_add_f64 v86, v[80:81]
  v_cmp_le_i32 vcc, 0, v20
  s_nop 0
  s_and_b64 vcc, vcc, s[54:55]
  s_cbranch_vccz L_gb_s3_0
  v_mov_b32_dpp v75, v96 quad_perm:[3,3,3,3] row_mask:0xf bank_mask:0xf
  v_mov_b32_dpp v91, v97 quad_perm:[3,3,3,3] row_mask:0xf bank_mask:0xf
  s_nop 0
  v_perm_b32 v91, v91, v75, v68
  v_add_u32_dpp v87, v20, v5 quad_perm:[3,3,3,3] row_mask:0xf bank_mask:0xf
  s_nop 1
  v_mul_f32_dpp v91, v30, v91 quad_perm:[3,3,3,3] row_mask:0xf bank_mask:0xf
  v_cvt_f64_f32 v[82:83], v91
  ds_add_f64 v87, v[82:83]
L_gb_s3_0:
  ds_read_b32 v20, v2 offset:1024
  ds_read_u16_d16_hi v30, v3 offset:512
  s_waitcnt lgkmcnt(8)
  v_and_b32 v70, 0x1fffff, v22
  v_ashrrev_i32 v22, 16, v22
  buffer_load_dwordx2 v[100:101], v70, s[12:15], 0 offen
  v_and_b32 v22, 0x8000ffe0, v22
  s_waitcnt vmcnt(1)
  s_waitcnt lgkmcnt(9)
  v_mov_b32_dpp v72, v98 quad_perm:[0,0,0,0] row_mask:0xf bank_mask:0xf
  v_mov_b32_dpp v73, v98 quad_perm:[1,1,1,1] row_mask:0xf bank_mask:0xf
  v_mov_b32_dpp v74, v98 quad_perm:[2,2,2,2] row_mask:0xf bank_mask:0xf
  v_mov_b32_dpp v88, v99 quad_perm:[0,0,0,0] row_mask:0xf bank_mask:0xf
  v_mov_b32_dpp v89, v99 quad_perm:[1,1,1,1] row_mask:0xf bank_mask:0xf
  v_mov_b32_dpp v90, v99 quad_perm:[2,2,2,2] row_mask:0xf bank_mask:0xf
  v_perm_b32 v88, v88, v72, v68
  v_perm_b32 v89, v89, v73, v68
  v_perm_b32 v90, v90, v74, v68
  v_add_u32_dpp v84, v21, v5 quad_perm:[0,0,0,0] row_mask:0xf bank_mask:0xf
  v_add_u32_dpp v85, v21, v5 quad_perm:[1,1,1,1] row_mask:0xf bank_mask:0xf
  v_add_u32_dpp v86, v21, v5 quad_perm:[2,2,2,2] row_mask:0xf bank_mask:0xf
  v_mul_f32_dpp v88, v31, v88 quad_perm:[0,0,0,0] row_mask:0xf bank_mask:0xf
  v_mul_f32_dpp v89, v31, v89 quad_perm:[1,1,1,1] row_mask:0xf bank_mask:0xf
  v_mul_f32_dpp v90, v31, v90 quad_perm:[2,2,2,2] row_mask:0xf bank_mask:0xf
  v_cvt_f64_f32 v[76:77], v88
  v_cvt_f64_f32 v[78:79], v89
  v_cvt_f64_f32 v[80:81], v90
  ds_add_f64 v84, v[76:77]
  ds_add_f64 v85, v[78:79]
  ds_add_f64 v86, v[80:81]
  v_cmp_le_i32 vcc, 0, v21
  s_nop 0
  s_and_b64 vcc, vcc, s[54:55]
  s_cbranch_vccz L_gb_s3_1
  v_mov_b32_dpp v75, v98 quad_perm:[3,3,3,3] row_mask:0xf bank_mask:0xf
  v_mov_b32_dpp v91, v99 quad_perm:[3,3,3,3] row_mask:0xf bank_mask:0xf
  s_nop 0
  v_perm_b32 v91, v91, v75, v68
  v_add_u32_dpp v87, v21, v5 quad_perm:[3,3,3,3] row_mask:0xf bank_mask:0xf
  s_nop 1
  v_mul_f32_dpp v91, v31, v91 quad_perm:[3,3,3,3] row_mask:0xf bank_mask:0xf
  v_cvt_f64_f32 v[82:83], v91
  ds_add_f64 v87, v[82:83]
L_gb_s3_1:
  ds_read_b32 v21, v2 offset:1280
  ds_read_u16_d16_hi v31, v3 offset:640
  s_waitcnt lgkmcnt(11)
  v_and_b32 v70, 0x1fffff, v23
  v_ashrrev_i32 v23, 16, v23
  buffer_load_dwordx2 v[96:97], v70, s[12:15], 0 offen
  v_and_b32 v23, 0x8000ffe0, v23
  s_waitcnt vmcnt(1)
  s_waitcnt lgkmcnt(12)
  v_mov_b32_dpp v72, v100 quad_perm:[0,0,0,0] row_mask:0xf bank_mask:0xf
  v_mov_b32_dpp v73, v100 quad_perm:[1,1,1,1] row_mask:0xf bank_mask:0xf
  v_mov_b32_dpp v74, v100 quad_perm:[2,2,2,2] row_mask:0xf bank_mask:0xf
  v_mov_b32_dpp v88, v101 quad_perm:[0,0,0,0] row_mask:0xf bank_mask:0xf
  v_mov_b32_dpp v89, v101 quad_perm:[1,1,1,1] row_mask:0xf bank_mask:0xf
  v_mov_b32_dpp v90, v101 quad_perm:[2,2,2,2] row_mask:0xf bank_mask:0xf
  v_perm_b32 v88, v88, v72, v68
  v_perm_b32 v89, v89, v73, v68
  v_perm_b32 v90, v90, v74, v68
  v_add_u32_dpp v84, v22, v5 quad_perm:[0,0,0,0] row_mask:0xf bank_mask:0xf
  v_add_u32_dpp v85, v22, v5 quad_perm:[1,1,1,1] row_mask:0xf bank_mask:0xf
  v_add_u32_dpp v86, v22, v5 quad_perm:[2,2,2,2] row_mask:0xf bank_mask:0xf
  v_mul_f32_dpp v88, v32, v88 quad_perm:[0,0,0,0] row_mask:0xf bank_mask:0xf
  v_mul_f32_dpp v89, v32, v89 quad_perm:[1,1,1,1] row_mask:0xf bank_mask:0xf
  v_mul_f32_dpp v90, v32, v90 quad_perm:[2,2,2,2] row_mask:0xf bank_mask:0xf
  v_cvt_f64_f32 v[76:77], v88
  v_cvt_f64_f32 v[78:79], v89
  v_cvt_f64_f32 v[80:81], v90
  ds_add_f64 v84, v[76:77]
  ds_add_f64 v85, v[78:79]
  ds_add_f64 v86, v[80:81]
  v_cmp_le_i32 vcc, 0, v22
  s_nop 0
  s_and_b64 vcc, vcc, s[54:55]
  s_cbranch_vccz L_gb_s3_2
  v_mov_b32_dpp v75, v100 quad_perm:[3,3,3,3] row_mask:0xf bank_mask:0xf
  v_mov_b32_dpp v91, v101 quad_perm:[3,3,3,3] row_mask:0xf bank_mask:0xf
  s_nop 0
  v_perm_b32 v91, v91, v75, v68
  v_add_u32_dpp v87, v22, v5 quad_perm:[3,3,3,3] row_mask:0xf bank_mask:0xf
  s_nop 1
  v_mul_f32_dpp v91, v32, v91 quad_perm:[3,3,3,3] row_mask:0xf bank_mask:0xf
  v_cvt_f64_f32 v[82:83], v91
  ds_add_f64 v87, v[82:83]
L_gb_s3_2:
  ds_read_b32 v22, v2 offset:1536
  ds_read_u16_d16_hi v32, v3 offset:768
  s_waitcnt lgkmcnt(11)
  v_and_b32 v70, 0x1fffff, v20
  v_ashrrev_i32 v20, 16, v20
  buffer_load_dwordx2 v[98:99], v70, s[12:15], 0 offen
  v_and_b32 v20, 0x8000ffe0, v20
  s_waitcnt vmcnt(1)
  s_waitcnt lgkmcnt(15)
  v_mov_b32_dpp v72, v96 quad_perm:[0,0,0,0] row_mask:0xf bank_mask:0xf
  v_mov_b32_dpp v73, v96 quad_perm:[1,1,1,1] row_mask:0xf bank_mask:0xf
  v_mov_b32_dpp v74, v96 quad_perm:[2,2,2,2] row_mask:0xf bank_mask:0xf
  v_mov_b32_dpp v88, v97 quad_perm:[0,0,0,0] row_mask:0xf bank_mask:0xf
  v_mov_b32_dpp v89, v97 quad_perm:[1,1,1,1] row_mask:0xf bank_mask:0xf
  v_mov_b32_dpp v90, v97 quad_perm:[2,2,2,2] row_mask:0xf bank_mask:0xf
  v_perm_b32 v88, v88, v72, v68
  v_perm_b32 v89, v89, v73, v68
  v_perm_b32 v90, v90, v74, v68
  v_add_u32_dpp v84, v23, v5 quad_perm:[0,0,0,0] row_mask:0xf bank_mask:0xf
  v_add_u32_dpp v85, v23, v5 quad_perm:[1,1,1,1] row_mask:0xf bank_mask:0xf
  v_add_u32_dpp v86, v23, v5 quad_perm:[2,2,2,2] row_mask:0xf bank_mask:0xf
  v_mul_f32_dpp v88, v33, v88 quad_perm:[0,0,0,0] row_mask:0xf bank_mask:0xf
  v_mul_f32_dpp v89, v33, v89 quad_perm:[1,1,1,1] row_mask:0xf bank_mask:0xf
  v_mul_f32_dpp v90, v33, v90 quad_perm:[2,2,2,2] row_mask:0xf bank_mask:0xf
  v_cvt_f64_f32 v[76:77], v88
  v_cvt_f64_f32 v[78:79], v89
  v_cvt_f64_f32 v[80:81], v90
  ds_add_f64 v84, v[76:77]
  ds_add_f64 v85, v[78:79]
  ds_add_f64 v86, v[80:81]
  v_cmp_le_i32 vcc, 0, v23
  s_nop 0
  s_and_b64 vcc, vcc, s[54:55]
  s_cbranch_vccz L_gb_s3_3
  v_mov_b32_dpp v75, v96 quad_perm:[3,3,3,3] row_mask:0xf bank_mask:0xf
  v_mov_b32_dpp v91, v97 quad_perm:[3,3,3,3] row_mask:0xf bank_mask:0xf
  s_nop 0
  v_perm_b32 v91, v91, v75, v68
  v_add_u32_dpp v87, v23, v5 quad_perm:[3,3,3,3] row_mask:0xf bank_mask:0xf
  s_nop 1
  v_mul_f32_dpp v91, v33, v91 quad_perm:[3,3,3,3] row_mask:0xf bank_mask:0xf
  v_cvt_f64_f32 v[82:83], v91
  ds_add_f64 v87, v[82:83]
L_gb_s3_3:
  ds_read_b32 v23, v2 offset:1792
  ds_read_u16_d16_hi v33, v3 offset:896
  s_waitcnt lgkmcnt(11)
  v_and_b32 v70, 0x1fffff, v21
  v_ashrrev_i32 v21, 16, v21
  buffer_load_dwordx2 v[100:101], v70, s[12:15], 0 offen
  v_and_b32 v21, 0x8000ffe0, v21
  s_waitcnt vmcnt(1)
  s_waitcnt lgkmcnt(15)
  v_mov_b32_dpp v72, v98 quad_perm:[0,0,0,0] row_mask:0xf bank_mask:0xf
  v_mov_b32_dpp v73, v98 quad_perm:[1,1,1,1] row_mask:0xf bank_mask:0xf
  v_mov_b32_dpp v74, v98 quad_perm:[2,2,2,2] row_mask:0xf bank_mask:0xf
  v_mov_b32_dpp v88, v99 quad_perm:[0,0,0,0] row_mask:0xf bank_mask:0xf
  v_mov_b32_dpp v89, v99 quad_perm:[1,1,1,1] row_mask:0xf bank_mask:0xf
  v_mov_b32_dpp v90, v99 quad_perm:[2,2,2,2] row_mask:0xf bank_mask:0xf
  v_perm_b32 v88, v88, v72, v68
  v_perm_b32 v89, v89, v73, v68
  v_perm_b32 v90, v90, v74, v68
  v_add_u32_dpp v84, v20, v5 quad_perm:[0,0,0,0] row_mask:0xf bank_mask:0xf
  v_add_u32_dpp v85, v20, v5 quad_perm:[1,1,1,1] row_mask:0xf bank_mask:0xf
  v_add_u32_dpp v86, v20, v5 quad_perm:[2,2,2,2] row_mask:0xf bank_mask:0xf
  v_mul_f32_dpp v88, v30, v88 quad_perm:[0,0,0,0] row_mask:0xf bank_mask:0xf
  v_mul_f32_dpp v89, v30, v89 quad_perm:[1,1,1,1] row_mask:0xf bank_mask:0xf
  v_mul_f32_dpp v90, v30, v90 quad_perm:[2,2,2,2] row_mask:0xf bank_mask:0xf
  v_cvt_f64_f32 v[76:77], v88
  v_cvt_f64_f32 v[78:79], v89
  v_cvt_f64_f32 v[80:81], v90
  ds_add_f64 v84, v[76:77]
  ds_add_f64 v85, v[78:79]
  ds_add_f64 v86, v[80:81]
  v_cmp_le_i32 vcc, 0, v20
  s_nop 0
  s_and_b64 vcc, vcc, s[54:55]
  s_cbranch_vccz L_gb_s3_4
  v_mov_b32_dpp v75, v98 quad_perm:[3,3,3,3] row_mask:0xf bank_mask:0xf
  v_mov_b32_dpp v91, v99 quad_perm:[3,3,3,3] row_mask:0xf bank_mask:0xf
  s_nop 0
  v_perm_b32 v91, v91, v75, v68
  v_add_u32_dpp v87, v20, v5 quad_perm:[3,3,3,3] row_mask:0xf bank_mask:0xf
  s_nop 1
  v_mul_f32_dpp v91, v30, v91 quad_perm:[3,3,3,3] row_mask:0xf bank_mask:0xf
  v_cvt_f64_f32 v[82:83], v91
  ds_add_f64 v87, v[82:83]
L_gb_s3_4:
  ds_read_b32 v20, v2 offset:2048
  ds_read_u16_d16_hi v30, v3 offset:1024
  s_waitcnt lgkmcnt(11)
  v_and_b32 v70, 0x1fffff, v22
  v_ashrrev_i32 v22, 16, v22
  buffer_load_dwordx2 v[96:97], v70, s[12:15], 0 offen
  v_and_b32 v22, 0x8000ffe0, v22
  s_waitcnt vmcnt(1)
  s_waitcnt lgkmcnt(15)
  v_mov_b32_dpp v72, v100 quad_perm:[0,0,0,0] row_mask:0xf bank_mask:0xf
  v_mov_b32_dpp v73, v100 quad_perm:[1,1,1,1] row_mask:0xf bank_mask:0xf
  v_mov_b32_dpp v74, v100 quad_perm:[2,2,2,2] row_mask:0xf bank_mask:0xf
  v_mov_b32_dpp v88, v101 quad_perm:[0,0,0,0] row_mask:0xf bank_mask:0xf
  v_mov_b32_dpp v89, v101 quad_perm:[1,1,1,1] row_mask:0xf bank_mask:0xf
  v_mov_b32_dpp v90, v101 quad_perm:[2,2,2,2] row_mask:0xf bank_mask:0xf
  v_perm_b32 v88, v88, v72, v68
  v_perm_b32 v89, v89, v73, v68
  v_perm_b32 v90, v90, v74, v68
  v_add_u32_dpp v84, v21, v5 quad_perm:[0,0,0,0] row_mask:0xf bank_mask:0xf
  v_add_u32_dpp v85, v21, v5 quad_perm:[1,1,1,1] row_mask:0xf bank_mask:0xf
  v_add_u32_dpp v86, v21, v5 quad_perm:[2,2,2,2] row_mask:0xf bank_mask:0xf
  v_mul_f32_dpp v88, v31, v88 quad_perm:[0,0,0,0] row_mask:0xf bank_mask:0xf
  v_mul_f32_dpp v89, v31, v89 quad_perm:[1,1,1,1] row_mask:0xf bank_mask:0xf
  v_mul_f32_dpp v90, v31, v90 quad_perm:[2,2,2,2] row_mask:0xf bank_mask:0xf
  v_cvt_f64_f32 v[76:77], v88
  v_cvt_f64_f32 v[78:79], v89
  v_cvt_f64_f32 v[80:81], v90
  ds_add_f64 v84, v[76:77]
  ds_add_f64 v85, v[78:79]
  ds_add_f64 v86, v[80:81]
  v_cmp_le_i32 vcc, 0, v21
  s_nop 0
  s_and_b64 vcc, vcc, s[54:55]
  s_cbranch_vccz L_gb_s3_5
  v_mov_b32_dpp v75, v100 quad_perm:[3,3,3,3] row_mask:0xf bank_mask:0xf
  v_mov_b32_dpp v91, v101 quad_perm:[3,3,3,3] row_mask:0xf bank_mask:0xf
  s_nop 0
  v_perm_b32 v91, v91, v75, v68
  v_add_u32_dpp v87, v21, v5 quad_perm:[3,3,3,3] row_mask:0xf bank_mask:0xf
  s_nop 1
  v_mul_f32_dpp v91, v31, v91 quad_perm:[3,3,3,3] row_mask:0xf bank_mask:0xf
  v_cvt_f64_f32 v[82:83], v91
  ds_add_f64 v87, v[82:83]
L_gb_s3_5:
  ds_read_b32 v21, v2 offset:2304
  ds_read_u16_d16_hi v31, v3 offset:1152
  s_waitcnt lgkmcnt(11)
  v_and_b32 v70, 0x1fffff, v23
  v_ashrrev_i32 v23, 16, v23
  buffer_load_dwordx2 v[98:99], v70, s[12:15], 0 offen
  v_and_b32 v23, 0x8000ffe0, v23
  s_waitcnt vmcnt(1)
  s_waitcnt lgkmcnt(15)
  v_mov_b32_dpp v72, v96 quad_perm:[0,0,0,0] row_mask:0xf bank_mask:0xf
  v_mov_b32_dpp v73, v96 quad_perm:[1,1,1,1] row_mask:0xf bank_mask:0xf
  v_mov_b32_dpp v74, v96 quad_perm:[2,2,2,2] row_mask:0xf bank_mask:0xf
  v_mov_b32_dpp v88, v97 quad_perm:[0,0,0,0] row_mask:0xf bank_mask:0xf
  v_mov_b32_dpp v89, v97 quad_perm:[1,1,1,1] row_mask:0xf bank_mask:0xf
  v_mov_b32_dpp v90, v97 quad_perm:[2,2,2,2] row_mask:0xf bank_mask:0xf
  v_perm_b32 v88, v88, v72, v68
  v_perm_b32 v89, v89, v73, v68
  v_perm_b32 v90, v90, v74, v68
  v_add_u32_dpp v84, v22, v5 quad_perm:[0,0,0,0] row_mask:0xf bank_mask:0xf
  v_add_u32_dpp v85, v22, v5 quad_perm:[1,1,1,1] row_mask:0xf bank_mask:0xf
  v_add_u32_dpp v86, v22, v5 quad_perm:[2,2,2,2] row_mask:0xf bank_mask:0xf
  v_mul_f32_dpp v88, v32, v88 quad_perm:[0,0,0,0] row_mask:0xf bank_mask:0xf
  v_mul_f32_dpp v89, v32, v89 quad_perm:[1,1,1,1] row_mask:0xf bank_mask:0xf
  v_mul_f32_dpp v90, v32, v90 quad_perm:[2,2,2,2] row_mask:0xf bank_mask:0xf
  v_cvt_f64_f32 v[76:77], v88
  v_cvt_f64_f32 v[78:79], v89
  v_cvt_f64_f32 v[80:81], v90
  ds_add_f64 v84, v[76:77]
  ds_add_f64 v85, v[78:79]
  ds_add_f64 v86, v[80:81]
  v_cmp_le_i32 vcc, 0, v22
  s_nop 0
  s_and_b64 vcc, vcc, s[54:55]
  s_cbranch_vccz L_gb_s3_6
  v_mov_b32_dpp v75, v96 quad_perm:[3,3,3,3] row_mask:0xf bank_mask:0xf
  v_mov_b32_dpp v91, v97 quad_perm:[3,3,3,3] row_mask:0xf bank_mask:0xf
  s_nop 0
  v_perm_b32 v91, v91, v75, v68
  v_add_u32_dpp v87, v22, v5 quad_perm:[3,3,3,3] row_mask:0xf bank_mask:0xf
  s_nop 1
  v_mul_f32_dpp v91, v32, v91 quad_perm:[3,3,3,3] row_mask:0xf bank_mask:0xf
  v_cvt_f64_f32 v[82:83], v91
  ds_add_f64 v87, v[82:83]
L_gb_s3_6:
  ds_read_b32 v22, v2 offset:2560
  ds_read_u16_d16_hi v32, v3 offset:1280
  s_waitcnt lgkmcnt(11)
  v_and_b32 v70, 0x1fffff, v20
  v_ashrrev_i32 v20, 16, v20
  buffer_load_dwordx2 v[100:101], v70, s[12:15], 0 offen
  v_and_b32 v20, 0x8000ffe0, v20
  s_waitcnt vmcnt(1)
  s_waitcnt lgkmcnt(15)
  v_mov_b32_dpp v72, v98 quad_perm:[0,0,0,0] row_mask:0xf bank_mask:0xf
  v_mov_b32_dpp v73, v98 quad_perm:[1,1,1,1] row_mask:0xf bank_mask:0xf
  v_mov_b32_dpp v74, v98 quad_perm:[2,2,2,2] row_mask:0xf bank_mask:0xf
  v_mov_b32_dpp v88, v99 quad_perm:[0,0,0,0] row_mask:0xf bank_mask:0xf
  v_mov_b32_dpp v89, v99 quad_perm:[1,1,1,1] row_mask:0xf bank_mask:0xf
  v_mov_b32_dpp v90, v99 quad_perm:[2,2,2,2] row_mask:0xf bank_mask:0xf
  v_perm_b32 v88, v88, v72, v68
  v_perm_b32 v89, v89, v73, v68
  v_perm_b32 v90, v90, v74, v68
  v_add_u32_dpp v84, v23, v5 quad_perm:[0,0,0,0] row_mask:0xf bank_mask:0xf
  v_add_u32_dpp v85, v23, v5 quad_perm:[1,1,1,1] row_mask:0xf bank_mask:0xf
  v_add_u32_dpp v86, v23, v5 quad_perm:[2,2,2,2] row_mask:0xf bank_mask:0xf
  v_mul_f32_dpp v88, v33, v88 quad_perm:[0,0,0,0] row_mask:0xf bank_mask:0xf
  v_mul_f32_dpp v89, v33, v89 quad_perm:[1,1,1,1] row_mask:0xf bank_mask:0xf
  v_mul_f32_dpp v90, v33, v90 quad_perm:[2,2,2,2] row_mask:0xf bank_mask:0xf
  v_cvt_f64_f32 v[76:77], v88
  v_cvt_f64_f32 v[78:79], v89
  v_cvt_f64_f32 v[80:81], v90
  ds_add_f64 v84, v[76:77]
  ds_add_f64 v85, v[78:79]
  ds_add_f64 v86, v[80:81]
  v_cmp_le_i32 vcc, 0, v23
  s_nop 0
  s_and_b64 vcc, vcc, s[54:55]
  s_cbranch_vccz L_gb_s3_7
  v_mov_b32_dpp v75, v98 quad_perm:[3,3,3,3] row_mask:0xf bank_mask:0xf
  v_mov_b32_dpp v91, v99 quad_perm:[3,3,3,3] row_mask:0xf bank_mask:0xf
  s_nop 0
  v_perm_b32 v91, v91, v75, v68
  v_add_u32_dpp v87, v23, v5 quad_perm:[3,3,3,3] row_mask:0xf bank_mask:0xf
  s_nop 1
  v_mul_f32_dpp v91, v33, v91 quad_perm:[3,3,3,3] row_mask:0xf bank_mask:0xf
  v_cvt_f64_f32 v[82:83], v91
  ds_add_f64 v87, v[82:83]
L_gb_s3_7:
  ds_read_b32 v23, v2 offset:2816
  ds_read_u16_d16_hi v33, v3 offset:1408
  s_waitcnt lgkmcnt(11)
  v_and_b32 v70, 0x1fffff, v21
  v_ashrrev_i32 v21, 16, v21
  buffer_load_dwordx2 v[96:97], v70, s[12:15], 0 offen
  v_and_b32 v21, 0x8000ffe0, v21
  s_waitcnt vmcnt(1)
  s_waitcnt lgkmcnt(15)
  v_mov_b32_dpp v72, v100 quad_perm:[0,0,0,0] row_mask:0xf bank_mask:0xf
  v_mov_b32_dpp v73, v100 quad_perm:[1,1,1,1] row_mask:0xf bank_mask:0xf
  v_mov_b32_dpp v74, v100 quad_perm:[2,2,2,2] row_mask:0xf bank_mask:0xf
  v_mov_b32_dpp v88, v101 quad_perm:[0,0,0,0] row_mask:0xf bank_mask:0xf
  v_mov_b32_dpp v89, v101 quad_perm:[1,1,1,1] row_mask:0xf bank_mask:0xf
  v_mov_b32_dpp v90, v101 quad_perm:[2,2,2,2] row_mask:0xf bank_mask:0xf
  v_perm_b32 v88, v88, v72, v68
  v_perm_b32 v89, v89, v73, v68
  v_perm_b32 v90, v90, v74, v68
  v_add_u32_dpp v84, v20, v5 quad_perm:[0,0,0,0] row_mask:0xf bank_mask:0xf
  v_add_u32_dpp v85, v20, v5 quad_perm:[1,1,1,1] row_mask:0xf bank_mask:0xf
  v_add_u32_dpp v86, v20, v5 quad_perm:[2,2,2,2] row_mask:0xf bank_mask:0xf
  v_mul_f32_dpp v88, v30, v88 quad_perm:[0,0,0,0] row_mask:0xf bank_mask:0xf
  v_mul_f32_dpp v89, v30, v89 quad_perm:[1,1,1,1] row_mask:0xf bank_mask:0xf
  v_mul_f32_dpp v90, v30, v90 quad_perm:[2,2,2,2] row_mask:0xf bank_mask:0xf
  v_cvt_f64_f32 v[76:77], v88
  v_cvt_f64_f32 v[78:79], v89
  v_cvt_f64_f32 v[80:81], v90
  ds_add_f64 v84, v[76:77]
  ds_add_f64 v85, v[78:79]
  ds_add_f64 v86, v[80:81]
  v_cmp_le_i32 vcc, 0, v20
  s_nop 0
  s_and_b64 vcc, vcc, s[54:55]
  s_cbranch_vccz L_gb_s3_8
  v_mov_b32_dpp v75, v100 quad_perm:[3,3,3,3] row_mask:0xf bank_mask:0xf
  v_mov_b32_dpp v91, v101 quad_perm:[3,3,3,3] row_mask:0xf bank_mask:0xf
  s_nop 0
  v_perm_b32 v91, v91, v75, v68
  v_add_u32_dpp v87, v20, v5 quad_perm:[3,3,3,3] row_mask:0xf bank_mask:0xf
  s_nop 1
  v_mul_f32_dpp v91, v30, v91 quad_perm:[3,3,3,3] row_mask:0xf bank_mask:0xf
  v_cvt_f64_f32 v[82:83], v91
  ds_add_f64 v87, v[82:83]
L_gb_s3_8:
  ds_read_b32 v20, v2 offset:3072
  ds_read_u16_d16_hi v30, v3 offset:1536
  s_waitcnt lgkmcnt(11)
  v_and_b32 v70, 0x1fffff, v22
  v_ashrrev_i32 v22, 16, v22
  buffer_load_dwordx2 v[98:99], v70, s[12:15], 0 offen
  v_and_b32 v22, 0x8000ffe0, v22
  s_waitcnt vmcnt(1)
  s_waitcnt lgkmcnt(15)
  v_mov_b32_dpp v72, v96 quad_perm:[0,0,0,0] row_mask:0xf bank_mask:0xf
  v_mov_b32_dpp v73, v96 quad_perm:[1,1,1,1] row_mask:0xf bank_mask:0xf
  v_mov_b32_dpp v74, v96 quad_perm:[2,2,2,2] row_mask:0xf bank_mask:0xf
  v_mov_b32_dpp v88, v97 quad_perm:[0,0,0,0] row_mask:0xf bank_mask:0xf
  v_mov_b32_dpp v89, v97 quad_perm:[1,1,1,1] row_mask:0xf bank_mask:0xf
  v_mov_b32_dpp v90, v97 quad_perm:[2,2,2,2] row_mask:0xf bank_mask:0xf
  v_perm_b32 v88, v88, v72, v68
  v_perm_b32 v89, v89, v73, v68
  v_perm_b32 v90, v90, v74, v68
  v_add_u32_dpp v84, v21, v5 quad_perm:[0,0,0,0] row_mask:0xf bank_mask:0xf
  v_add_u32_dpp v85, v21, v5 quad_perm:[1,1,1,1] row_mask:0xf bank_mask:0xf
  v_add_u32_dpp v86, v21, v5 quad_perm:[2,2,2,2] row_mask:0xf bank_mask:0xf
  v_mul_f32_dpp v88, v31, v88 quad_perm:[0,0,0,0] row_mask:0xf bank_mask:0xf
  v_mul_f32_dpp v89, v31, v89 quad_perm:[1,1,1,1] row_mask:0xf bank_mask:0xf
  v_mul_f32_dpp v90, v31, v90 quad_perm:[2,2,2,2] row_mask:0xf bank_mask:0xf
  v_cvt_f64_f32 v[76:77], v88
  v_cvt_f64_f32 v[78:79], v89
  v_cvt_f64_f32 v[80:81], v90
  ds_add_f64 v84, v[76:77]
  ds_add_f64 v85, v[78:79]
  ds_add_f64 v86, v[80:81]
  v_cmp_le_i32 vcc, 0, v21
  s_nop 0
  s_and_b64 vcc, vcc, s[54:55]
  s_cbranch_vccz L_gb_s3_9
  v_mov_b32_dpp v75, v96 quad_perm:[3,3,3,3] row_mask:0xf bank_mask:0xf
  v_mov_b32_dpp v91, v97 quad_perm:[3,3,3,3] row_mask:0xf bank_mask:0xf
  s_nop 0
  v_perm_b32 v91, v91, v75, v68
  v_add_u32_dpp v87, v21, v5 quad_perm:[3,3,3,3] row_mask:0xf bank_mask:0xf
  s_nop 1
  v_mul_f32_dpp v91, v31, v91 quad_perm:[3,3,3,3] row_mask:0xf bank_mask:0xf
  v_cvt_f64_f32 v[82:83], v91
  ds_add_f64 v87, v[82:83]
L_gb_s3_9:
  ds_read_b32 v21, v2 offset:3328
  ds_read_u16_d16_hi v31, v3 offset:1664
  s_waitcnt lgkmcnt(11)
  v_and_b32 v70, 0x1fffff, v23
  v_ashrrev_i32 v23, 16, v23
  buffer_load_dwordx2 v[100:101], v70, s[12:15], 0 offen
  v_and_b32 v23, 0x8000ffe0, v23
  s_waitcnt vmcnt(1)
  s_waitcnt lgkmcnt(15)
  v_mov_b32_dpp v72, v98 quad_perm:[0,0,0,0] row_mask:0xf bank_mask:0xf
  v_mov_b32_dpp v73, v98 quad_perm:[1,1,1,1] row_mask:0xf bank_mask:0xf
  v_mov_b32_dpp v74, v98 quad_perm:[2,2,2,2] row_mask:0xf bank_mask:0xf
  v_mov_b32_dpp v88, v99 quad_perm:[0,0,0,0] row_mask:0xf bank_mask:0xf
  v_mov_b32_dpp v89, v99 quad_perm:[1,1,1,1] row_mask:0xf bank_mask:0xf
  v_mov_b32_dpp v90, v99 quad_perm:[2,2,2,2] row_mask:0xf bank_mask:0xf
  v_perm_b32 v88, v88, v72, v68
  v_perm_b32 v89, v89, v73, v68
  v_perm_b32 v90, v90, v74, v68
  v_add_u32_dpp v84, v22, v5 quad_perm:[0,0,0,0] row_mask:0xf bank_mask:0xf
  v_add_u32_dpp v85, v22, v5 quad_perm:[1,1,1,1] row_mask:0xf bank_mask:0xf
  v_add_u32_dpp v86, v22, v5 quad_perm:[2,2,2,2] row_mask:0xf bank_mask:0xf
  v_mul_f32_dpp v88, v32, v88 quad_perm:[0,0,0,0] row_mask:0xf bank_mask:0xf
  v_mul_f32_dpp v89, v32, v89 quad_perm:[1,1,1,1] row_mask:0xf bank_mask:0xf
  v_mul_f32_dpp v90, v32, v90 quad_perm:[2,2,2,2] row_mask:0xf bank_mask:0xf
  v_cvt_f64_f32 v[76:77], v88
  v_cvt_f64_f32 v[78:79], v89
  v_cvt_f64_f32 v[80:81], v90
  ds_add_f64 v84, v[76:77]
  ds_add_f64 v85, v[78:79]
  ds_add_f64 v86, v[80:81]
  v_cmp_le_i32 vcc, 0, v22
  s_nop 0
  s_and_b64 vcc, vcc, s[54:55]
  s_cbranch_vccz L_gb_s3_10
  v_mov_b32_dpp v75, v98 quad_perm:[3,3,3,3] row_mask:0xf bank_mask:0xf
  v_mov_b32_dpp v91, v99 quad_perm:[3,3,3,3] row_mask:0xf bank_mask:0xf
  s_nop 0
  v_perm_b32 v91, v91, v75, v68
  v_add_u32_dpp v87, v22, v5 quad_perm:[3,3,3,3] row_mask:0xf bank_mask:0xf
  s_nop 1
  v_mul_f32_dpp v91, v32, v91 quad_perm:[3,3,3,3] row_mask:0xf bank_mask:0xf
  v_cvt_f64_f32 v[82:83], v91
  ds_add_f64 v87, v[82:83]
L_gb_s3_10:
  ds_read_b32 v22, v2 offset:3584
  ds_read_u16_d16_hi v32, v3 offset:1792
  s_waitcnt lgkmcnt(11)
  v_and_b32 v70, 0x1fffff, v20
  v_ashrrev_i32 v20, 16, v20
  buffer_load_dwordx2 v[96:97], v70, s[12:15], 0 offen
  v_and_b32 v20, 0x8000ffe0, v20
  s_waitcnt vmcnt(1)
  s_waitcnt lgkmcnt(15)
  v_mov_b32_dpp v72, v100 quad_perm:[0,0,0,0] row_mask:0xf bank_mask:0xf
  v_mov_b32_dpp v73, v100 quad_perm:[1,1,1,1] row_mask:0xf bank_mask:0xf
  v_mov_b32_dpp v74, v100 quad_perm:[2,2,2,2] row_mask:0xf bank_mask:0xf
  v_mov_b32_dpp v88, v101 quad_perm:[0,0,0,0] row_mask:0xf bank_mask:0xf
  v_mov_b32_dpp v89, v101 quad_perm:[1,1,1,1] row_mask:0xf bank_mask:0xf
  v_mov_b32_dpp v90, v101 quad_perm:[2,2,2,2] row_mask:0xf bank_mask:0xf
  v_perm_b32 v88, v88, v72, v68
  v_perm_b32 v89, v89, v73, v68
  v_perm_b32 v90, v90, v74, v68
  v_add_u32_dpp v84, v23, v5 quad_perm:[0,0,0,0] row_mask:0xf bank_mask:0xf
  v_add_u32_dpp v85, v23, v5 quad_perm:[1,1,1,1] row_mask:0xf bank_mask:0xf
  v_add_u32_dpp v86, v23, v5 quad_perm:[2,2,2,2] row_mask:0xf bank_mask:0xf
  v_mul_f32_dpp v88, v33, v88 quad_perm:[0,0,0,0] row_mask:0xf bank_mask:0xf
  v_mul_f32_dpp v89, v33, v89 quad_perm:[1,1,1,1] row_mask:0xf bank_mask:0xf
  v_mul_f32_dpp v90, v33, v90 quad_perm:[2,2,2,2] row_mask:0xf bank_mask:0xf
  v_cvt_f64_f32 v[76:77], v88
  v_cvt_f64_f32 v[78:79], v89
  v_cvt_f64_f32 v[80:81], v90
  ds_add_f64 v84, v[76:77]
  ds_add_f64 v85, v[78:79]
  ds_add_f64 v86, v[80:81]
  v_cmp_le_i32 vcc, 0, v23
  s_nop 0
  s_and_b64 vcc, vcc, s[54:55]
  s_cbranch_vccz L_gb_s3_11
  v_mov_b32_dpp v75, v100 quad_perm:[3,3,3,3] row_mask:0xf bank_mask:0xf
  v_mov_b32_dpp v91, v101 quad_perm:[3,3,3,3] row_mask:0xf bank_mask:0xf
  s_nop 0
  v_perm_b32 v91, v91, v75, v68
  v_add_u32_dpp v87, v23, v5 quad_perm:[3,3,3,3] row_mask:0xf bank_mask:0xf
  s_nop 1
  v_mul_f32_dpp v91, v33, v91 quad_perm:[3,3,3,3] row_mask:0xf bank_mask:0xf
  v_cvt_f64_f32 v[82:83], v91
  ds_add_f64 v87, v[82:83]
L_gb_s3_11:
  ds_read_b32 v23, v2 offset:3840
  ds_read_u16_d16_hi v33, v3 offset:1920
  s_waitcnt lgkmcnt(11)
  v_and_b32 v70, 0x1fffff, v21
  v_ashrrev_i32 v21, 16, v21
  buffer_load_dwordx2 v[98:99], v70, s[12:15], 0 offen
  v_and_b32 v21, 0x8000ffe0, v21
  s_waitcnt vmcnt(1)
  s_waitcnt lgkmcnt(15)
  v_mov_b32_dpp v72, v96 quad_perm:[0,0,0,0] row_mask:0xf bank_mask:0xf
  v_mov_b32_dpp v73, v96 quad_perm:[1,1,1,1] row_mask:0xf bank_mask:0xf
  v_mov_b32_dpp v74, v96 quad_perm:[2,2,2,2] row_mask:0xf bank_mask:0xf
  v_mov_b32_dpp v88, v97 quad_perm:[0,0,0,0] row_mask:0xf bank_mask:0xf
  v_mov_b32_dpp v89, v97 quad_perm:[1,1,1,1] row_mask:0xf bank_mask:0xf
  v_mov_b32_dpp v90, v97 quad_perm:[2,2,2,2] row_mask:0xf bank_mask:0xf
  v_perm_b32 v88, v88, v72, v68
  v_perm_b32 v89, v89, v73, v68
  v_perm_b32 v90, v90, v74, v68
  v_add_u32_dpp v84, v20, v5 quad_perm:[0,0,0,0] row_mask:0xf bank_mask:0xf
  v_add_u32_dpp v85, v20, v5 quad_perm:[1,1,1,1] row_mask:0xf bank_mask:0xf
  v_add_u32_dpp v86, v20, v5 quad_perm:[2,2,2,2] row_mask:0xf bank_mask:0xf
  v_mul_f32_dpp v88, v30, v88 quad_perm:[0,0,0,0] row_mask:0xf bank_mask:0xf
  v_mul_f32_dpp v89, v30, v89 quad_perm:[1,1,1,1] row_mask:0xf bank_mask:0xf
  v_mul_f32_dpp v90, v30, v90 quad_perm:[2,2,2,2] row_mask:0xf bank_mask:0xf
  v_cvt_f64_f32 v[76:77], v88
  v_cvt_f64_f32 v[78:79], v89
  v_cvt_f64_f32 v[80:81], v90
  ds_add_f64 v84, v[76:77]
  ds_add_f64 v85, v[78:79]
  ds_add_f64 v86, v[80:81]
  v_cmp_le_i32 vcc, 0, v20
  s_nop 0
  s_and_b64 vcc, vcc, s[54:55]
  s_cbranch_vccz L_gb_s3_12
  v_mov_b32_dpp v75, v96 quad_perm:[3,3,3,3] row_mask:0xf bank_mask:0xf
  v_mov_b32_dpp v91, v97 quad_perm:[3,3,3,3] row_mask:0xf bank_mask:0xf
  s_nop 0
  v_perm_b32 v91, v91, v75, v68
  v_add_u32_dpp v87, v20, v5 quad_perm:[3,3,3,3] row_mask:0xf bank_mask:0xf
  s_nop 1
  v_mul_f32_dpp v91, v30, v91 quad_perm:[3,3,3,3] row_mask:0xf bank_mask:0xf
  v_cvt_f64_f32 v[82:83], v91
  ds_add_f64 v87, v[82:83]
L_gb_s3_12:
  s_waitcnt lgkmcnt(9)
  v_and_b32 v70, 0x1fffff, v22
  v_ashrrev_i32 v22, 16, v22
  buffer_load_dwordx2 v[100:101], v70, s[12:15], 0 offen
  v_and_b32 v22, 0x8000ffe0, v22
  s_waitcnt vmcnt(1)
  s_waitcnt lgkmcnt(13)
  v_mov_b32_dpp v72, v98 quad_perm:[0,0,0,0] row_mask:0xf bank_mask:0xf
  v_mov_b32_dpp v73, v98 quad_perm:[1,1,1,1] row_mask:0xf bank_mask:0xf
  v_mov_b32_dpp v74, v98 quad_perm:[2,2,2,2] row_mask:0xf bank_mask:0xf
  v_mov_b32_dpp v88, v99 quad_perm:[0,0,0,0] row_mask:0xf bank_mask:0xf
  v_mov_b32_dpp v89, v99 quad_perm:[1,1,1,1] row_mask:0xf bank_mask:0xf
  v_mov_b32_dpp v90, v99 quad_perm:[2,2,2,2] row_mask:0xf bank_mask:0xf
  v_perm_b32 v88, v88, v72, v68
  v_perm_b32 v89, v89, v73, v68
  v_perm_b32 v90, v90, v74, v68
  v_add_u32_dpp v84, v21, v5 quad_perm:[0,0,0,0] row_mask:0xf bank_mask:0xf
  v_add_u32_dpp v85, v21, v5 quad_perm:[1,1,1,1] row_mask:0xf bank_mask:0xf
  v_add_u32_dpp v86, v21, v5 quad_perm:[2,2,2,2] row_mask:0xf bank_mask:0xf
  v_mul_f32_dpp v88, v31, v88 quad_perm:[0,0,0,0] row_mask:0xf bank_mask:0xf
  v_mul_f32_dpp v89, v31, v89 quad_perm:[1,1,1,1] row_mask:0xf bank_mask:0xf
  v_mul_f32_dpp v90, v31, v90 quad_perm:[2,2,2,2] row_mask:0xf bank_mask:0xf
  v_cvt_f64_f32 v[76:77], v88
  v_cvt_f64_f32 v[78:79], v89
  v_cvt_f64_f32 v[80:81], v90
  ds_add_f64 v84, v[76:77]
  ds_add_f64 v85, v[78:79]
  ds_add_f64 v86, v[80:81]
  v_cmp_le_i32 vcc, 0, v21
  s_nop 0
  s_and_b64 vcc, vcc, s[54:55]
  s_cbranch_vccz L_gb_s3_13
  v_mov_b32_dpp v75, v98 quad_perm:[3,3,3,3] row_mask:0xf bank_mask:0xf
  v_mov_b32_dpp v91, v99 quad_perm:[3,3,3,3] row_mask:0xf bank_mask:0xf
  s_nop 0
  v_perm_b32 v91, v91, v75, v68
  v_add_u32_dpp v87, v21, v5 quad_perm:[3,3,3,3] row_mask:0xf bank_mask:0xf
  s_nop 1
  v_mul_f32_dpp v91, v31, v91 quad_perm:[3,3,3,3] row_mask:0xf bank_mask:0xf
  v_cvt_f64_f32 v[82:83], v91
  ds_add_f64 v87, v[82:83]
L_gb_s3_13:
  s_waitcnt lgkmcnt(7)
  v_and_b32 v70, 0x1fffff, v23
  v_ashrrev_i32 v23, 16, v23
  buffer_load_dwordx2 v[96:97], v70, s[12:15], 0 offen
  v_and_b32 v23, 0x8000ffe0, v23
  s_waitcnt vmcnt(1)
  s_waitcnt lgkmcnt(11)
  v_mov_b32_dpp v72, v100 quad_perm:[0,0,0,0] row_mask:0xf bank_mask:0xf
  v_mov_b32_dpp v73, v100 quad_perm:[1,1,1,1] row_mask:0xf bank_mask:0xf
  v_mov_b32_dpp v74, v100 quad_perm:[2,2,2,2] row_mask:0xf bank_mask:0xf
  v_mov_b32_dpp v88, v101 quad_perm:[0,0,0,0] row_mask:0xf bank_mask:0xf
  v_mov_b32_dpp v89, v101 quad_perm:[1,1,1,1] row_mask:0xf bank_mask:0xf
  v_mov_b32_dpp v90, v101 quad_perm:[2,2,2,2] row_mask:0xf bank_mask:0xf
  v_perm_b32 v88, v88, v72, v68
  v_perm_b32 v89, v89, v73, v68
  v_perm_b32 v90, v90, v74, v68
  v_add_u32_dpp v84, v22, v5 quad_perm:[0,0,0,0] row_mask:0xf bank_mask:0xf
  v_add_u32_dpp v85, v22, v5 quad_perm:[1,1,1,1] row_mask:0xf bank_mask:0xf
  v_add_u32_dpp v86, v22, v5 quad_perm:[2,2,2,2] row_mask:0xf bank_mask:0xf
  v_mul_f32_dpp v88, v32, v88 quad_perm:[0,0,0,0] row_mask:0xf bank_mask:0xf
  v_mul_f32_dpp v89, v32, v89 quad_perm:[1,1,1,1] row_mask:0xf bank_mask:0xf
  v_mul_f32_dpp v90, v32, v90 quad_perm:[2,2,2,2] row_mask:0xf bank_mask:0xf
  v_cvt_f64_f32 v[76:77], v88
  v_cvt_f64_f32 v[78:79], v89
  v_cvt_f64_f32 v[80:81], v90
  ds_add_f64 v84, v[76:77]
  ds_add_f64 v85, v[78:79]
  ds_add_f64 v86, v[80:81]
  v_cmp_le_i32 vcc, 0, v22
  s_nop 0
  s_and_b64 vcc, vcc, s[54:55]
  s_cbranch_vccz L_gb_s3_14
  v_mov_b32_dpp v75, v100 quad_perm:[3,3,3,3] row_mask:0xf bank_mask:0xf
  v_mov_b32_dpp v91, v101 quad_perm:[3,3,3,3] row_mask:0xf bank_mask:0xf
  s_nop 0
  v_perm_b32 v91, v91, v75, v68
  v_add_u32_dpp v87, v22, v5 quad_perm:[3,3,3,3] row_mask:0xf bank_mask:0xf
  s_nop 1
  v_mul_f32_dpp v91, v32, v91 quad_perm:[3,3,3,3] row_mask:0xf bank_mask:0xf
  v_cvt_f64_f32 v[82:83], v91
  ds_add_f64 v87, v[82:83]
L_gb_s3_14:
  s_waitcnt vmcnt(0)
  s_waitcnt lgkmcnt(9)
  v_mov_b32_dpp v72, v96 quad_perm:[0,0,0,0] row_mask:0xf bank_mask:0xf
  v_mov_b32_dpp v73, v96 quad_perm:[1,1,1,1] row_mask:0xf bank_mask:0xf
  v_mov_b32_dpp v74, v96 quad_perm:[2,2,2,2] row_mask:0xf bank_mask:0xf
  v_mov_b32_dpp v88, v97 quad_perm:[0,0,0,0] row_mask:0xf bank_mask:0xf
  v_mov_b32_dpp v89, v97 quad_perm:[1,1,1,1] row_mask:0xf bank_mask:0xf
  v_mov_b32_dpp v90, v97 quad_perm:[2,2,2,2] row_mask:0xf bank_mask:0xf
  v_perm_b32 v88, v88, v72, v68
  v_perm_b32 v89, v89, v73, v68
  v_perm_b32 v90, v90, v74, v68
  v_add_u32_dpp v84, v23, v5 quad_perm:[0,0,0,0] row_mask:0xf bank_mask:0xf
  v_add_u32_dpp v85, v23, v5 quad_perm:[1,1,1,1] row_mask:0xf bank_mask:0xf
  v_add_u32_dpp v86, v23, v5 quad_perm:[2,2,2,2] row_mask:0xf bank_mask:0xf
  v_mul_f32_dpp v88, v33, v88 quad_perm:[0,0,0,0] row_mask:0xf bank_mask:0xf
  v_mul_f32_dpp v89, v33, v89 quad_perm:[1,1,1,1] row_mask:0xf bank_mask:0xf
  v_mul_f32_dpp v90, v33, v90 quad_perm:[2,2,2,2] row_mask:0xf bank_mask:0xf
  v_cvt_f64_f32 v[76:77], v88
  v_cvt_f64_f32 v[78:79], v89
  v_cvt_f64_f32 v[80:81], v90
  ds_add_f64 v84, v[76:77]
  ds_add_f64 v85, v[78:79]
  ds_add_f64 v86, v[80:81]
  v_cmp_le_i32 vcc, 0, v23
  s_nop 0
  s_and_b64 vcc, vcc, s[54:55]
  s_cbranch_vccz L_gb_s3_15
  v_mov_b32_dpp v75, v96 quad_perm:[3,3,3,3] row_mask:0xf bank_mask:0xf
  v_mov_b32_dpp v91, v97 quad_perm:[3,3,3,3] row_mask:0xf bank_mask:0xf
  s_nop 0
  v_perm_b32 v91, v91, v75, v68
  v_add_u32_dpp v87, v23, v5 quad_perm:[3,3,3,3] row_mask:0xf bank_mask:0xf
  s_nop 1
  v_mul_f32_dpp v91, v33, v91 quad_perm:[3,3,3,3] row_mask:0xf bank_mask:0xf
  v_cvt_f64_f32 v[82:83], v91
  ds_add_f64 v87, v[82:83]
L_gb_s3_15:
  s_branch L_final
L_gather_dir:
  v_and_b32 v70, 31, v1
  v_and_b32 v71, 3, v70
  v_lshrrev_b32 v70, 2, v70
  v_lshl_add_u32 v70, v71, 3, v70
  v_lshrrev_b32 v71, 5, v1
  v_lshl_add_u32 v70, v71, 5, v70
  s_mul_i32 s97, s96, 384
  s_add_i32 s97, s97, 10240
  v_add_u32 v70, s97, v70
  v_lshlrev_b32 v2, 2, v70
  v_add_u32 v2, 47616, v2
  v_lshlrev_b32 v3, 1, v70
  v_add_u32 v3, 22528, v3
  v_mov_b32 v30, 0
  v_mov_b32 v31, 0
  v_mov_b32 v32, 0
  v_mov_b32 v33, 0
  s_mov_b32 s54, 0x88888888
  s_mov_b32 s55, 0x88888888
  s_waitcnt lgkmcnt(0)
  ds_read_b32 v20, v2 offset:0
  ds_read_u16_d16_hi v30, v3 offset:0
  ds_read_b32 v21, v2 offset:256
  ds_read_u16_d16_hi v31, v3 offset:128
  ds_read_b32 v22, v2 offset:512
  ds_read_u16_d16_hi v32, v3 offset:256
  s_waitcnt lgkmcnt(5)
  v_and_b32 v70, 0x1fffff, v20
  v_ashrrev_i32 v20, 16, v20
  buffer_load_dwordx2 v[96:97], v70, s[12:15], 0 offen
  v_and_b32 v20, 0x8000ffe0, v20
  ds_read_b32 v23, v2 offset:768
  ds_read_u16_d16_hi v33, v3 offset:384
  s_waitcnt lgkmcnt(5)
  v_and_b32 v70, 0x1fffff, v21
  v_ashrrev_i32 v21, 16, v21
  buffer_load_dwordx2 v[98:99], v70, s[12:15], 0 offen
  v_and_b32 v21, 0x8000ffe0, v21
  s_waitcnt vmcnt(1)
  s_waitcnt lgkmcnt(6)
  v_mov_b32_dpp v72, v96 quad_perm:[0,0,0,0] row_mask:0xf bank_mask:0xf
  v_mov_b32_dpp v73, v96 quad_perm:[1,1,1,1] row_mask:0xf bank_mask:0xf
  v_mov_b32_dpp v74, v96 quad_perm:[2,2,2,2] row_mask:0xf bank_mask:0xf
  v_mov_b32_dpp v88, v97 quad_perm:[0,0,0,0] row_mask:0xf bank_mask:0xf
  v_mov_b32_dpp v89, v97 quad_perm:[1,1,1,1] row_mask:0xf bank_mask:0xf
  v_mov_b32_dpp v90, v97 quad_perm:[2,2,2,2] row_mask:0xf bank_mask:0xf
  v_perm_b32 v88, v88, v72, v68
  v_perm_b32 v89, v89, v73, v68
  v_perm_b32 v90, v90, v74, v68
  v_add_u32_dpp v84, v20, v5 quad_perm:[0,0,0,0] row_mask:0xf bank_mask:0xf
  v_add_u32_dpp v85, v20, v5 quad_perm:[1,1,1,1] row_mask:0xf bank_mask:0xf
  v_add_u32_dpp v86, v20, v5 quad_perm:[2,2,2,2] row_mask:0xf bank_mask:0xf
  v_mul_f32_dpp v88, v30, v88 quad_perm:[0,0,0,0] row_mask:0xf bank_mask:0xf
  v_mul_f32_dpp v89, v30, v89 quad_perm:[1,1,1,1] row_mask:0xf bank_mask:0xf
  v_mul_f32_dpp v90, v30, v90 quad_perm:[2,2,2,2] row_mask:0xf bank_mask:0xf
  v_cvt_f64_f32 v[76:77], v88
  v_cvt_f64_f32 v[78:79], v89
  v_cvt_f64_f32 v[80:81], v90
  ds_add_f64 v84, v[76:77]
  ds_add_f64 v85, v[78:79]
  ds_add_f64 v86, v[80:81]
  v_cmp_le_i32 vcc, 0, v20
  s_nop 0
  s_and_b64 vcc, vcc, s[54:55]
  s_cbranch_vccz L_gd_s3_0
  v_mov_b32_dpp v75, v96 quad_perm:[3,3,3,3] row_mask:0xf bank_mask:0xf
  v_mov_b32_dpp v91, v97 quad_perm:[3,3,3,3] row_mask:0xf bank_mask:0xf
  s_nop 0
  v_perm_b32 v91, v91, v75, v68
  v_add_u32_dpp v87, v20, v5 quad_perm:[3,3,3,3] row_mask:0xf bank_mask:0xf
  s_nop 1
  v_mul_f32_dpp v91, v30, v91 quad_perm:[3,3,3,3] row_mask:0xf bank_mask:0xf
  v_cvt_f64_f32 v[82:83], v91
  ds_add_f64 v87, v[82:83]
L_gd_s3_0:
  ds_read_b32 v20, v2 offset:1024
  ds_read_u16_d16_hi v30, v3 offset:512
  s_waitcnt lgkmcnt(8)
  v_and_b32 v70, 0x1fffff, v22
  v_ashrrev_i32 v22, 16, v22
  buffer_load_dwordx2 v[100:101], v70, s[12:15], 0 offen
  v_and_b32 v22, 0x8000ffe0, v22
  s_waitcnt vmcnt(1)
  s_waitcnt lgkmcnt(9)
  v_mov_b32_dpp v72, v98 quad_perm:[0,0,0,0] row_mask:0xf bank_mask:0xf
  v_mov_b32_dpp v73, v98 quad_perm:[1,1,1,1] row_mask:0xf bank_mask:0xf
  v_mov_b32_dpp v74, v98 quad_perm:[2,2,2,2] row_mask:0xf bank_mask:0xf
  v_mov_b32_dpp v88, v99 quad_perm:[0,0,0,0] row_mask:0xf bank_mask:0xf
  v_mov_b32_dpp v89, v99 quad_perm:[1,1,1,1] row_mask:0xf bank_mask:0xf
  v_mov_b32_dpp v90, v99 quad_perm:[2,2,2,2] row_mask:0xf bank_mask:0xf
  v_perm_b32 v88, v88, v72, v68
  v_perm_b32 v89, v89, v73, v68
  v_perm_b32 v90, v90, v74, v68
  v_add_u32_dpp v84, v21, v5 quad_perm:[0,0,0,0] row_mask:0xf bank_mask:0xf
  v_add_u32_dpp v85, v21, v5 quad_perm:[1,1,1,1] row_mask:0xf bank_mask:0xf
  v_add_u32_dpp v86, v21, v5 quad_perm:[2,2,2,2] row_mask:0xf bank_mask:0xf
  v_mul_f32_dpp v88, v31, v88 quad_perm:[0,0,0,0] row_mask:0xf bank_mask:0xf
  v_mul_f32_dpp v89, v31, v89 quad_perm:[1,1,1,1] row_mask:0xf bank_mask:0xf
  v_mul_f32_dpp v90, v31, v90 quad_perm:[2,2,2,2] row_mask:0xf bank_mask:0xf
  v_cvt_f64_f32 v[76:77], v88
  v_cvt_f64_f32 v[78:79], v89
  v_cvt_f64_f32 v[80:81], v90
  ds_add_f64 v84, v[76:77]
  ds_add_f64 v85, v[78:79]
  ds_add_f64 v86, v[80:81]
  v_cmp_le_i32 vcc, 0, v21
  s_nop 0
  s_and_b64 vcc, vcc, s[54:55]
  s_cbranch_vccz L_gd_s3_1
  v_mov_b32_dpp v75, v98 quad_perm:[3,3,3,3] row_mask:0xf bank_mask:0xf
  v_mov_b32_dpp v91, v99 quad_perm:[3,3,3,3] row_mask:0xf bank_mask:0xf
  s_nop 0
  v_perm_b32 v91, v91, v75, v68
  v_add_u32_dpp v87, v21, v5 quad_perm:[3,3,3,3] row_mask:0xf bank_mask:0xf
  s_nop 1
  v_mul_f32_dpp v91, v31, v91 quad_perm:[3,3,3,3] row_mask:0xf bank_mask:0xf
  v_cvt_f64_f32 v[82:83], v91
  ds_add_f64 v87, v[82:83]
L_gd_s3_1:
  ds_read_b32 v21, v2 offset:1280
  ds_read_u16_d16_hi v31, v3 offset:640
  s_waitcnt lgkmcnt(11)
  v_and_b32 v70, 0x1fffff, v23
  v_ashrrev_i32 v23, 16, v23
  buffer_load_dwordx2 v[96:97], v70, s[12:15], 0 offen
  v_and_b32 v23, 0x8000ffe0, v23
  s_waitcnt vmcnt(1)
  s_waitcnt lgkmcnt(12)
  v_mov_b32_dpp v72, v100 quad_perm:[0,0,0,0] row_mask:0xf bank_mask:0xf
  v_mov_b32_dpp v73, v100 quad_perm:[1,1,1,1] row_mask:0xf bank_mask:0xf
  v_mov_b32_dpp v74, v100 quad_perm:[2,2,2,2] row_mask:0xf bank_mask:0xf
  v_mov_b32_dpp v88, v101 quad_perm:[0,0,0,0] row_mask:0xf bank_mask:0xf
  v_mov_b32_dpp v89, v101 quad_perm:[1,1,1,1] row_mask:0xf bank_mask:0xf
  v_mov_b32_dpp v90, v101 quad_perm:[2,2,2,2] row_mask:0xf bank_mask:0xf
  v_perm_b32 v88, v88, v72, v68
  v_perm_b32 v89, v89, v73, v68
  v_perm_b32 v90, v90, v74, v68
  v_add_u32_dpp v84, v22, v5 quad_perm:[0,0,0,0] row_mask:0xf bank_mask:0xf
  v_add_u32_dpp v85, v22, v5 quad_perm:[1,1,1,1] row_mask:0xf bank_mask:0xf
  v_add_u32_dpp v86, v22, v5 quad_perm:[2,2,2,2] row_mask:0xf bank_mask:0xf
  v_mul_f32_dpp v88, v32, v88 quad_perm:[0,0,0,0] row_mask:0xf bank_mask:0xf
  v_mul_f32_dpp v89, v32, v89 quad_perm:[1,1,1,1] row_mask:0xf bank_mask:0xf
  v_mul_f32_dpp v90, v32, v90 quad_perm:[2,2,2,2] row_mask:0xf bank_mask:0xf
  v_cvt_f64_f32 v[76:77], v88
  v_cvt_f64_f32 v[78:79], v89
  v_cvt_f64_f32 v[80:81], v90
  ds_add_f64 v84, v[76:77]
  ds_add_f64 v85, v[78:79]
  ds_add_f64 v86, v[80:81]
  v_cmp_le_i32 vcc, 0, v22
  s_nop 0
  s_and_b64 vcc, vcc, s[54:55]
  s_cbranch_vccz L_gd_s3_2
  v_mov_b32_dpp v75, v100 quad_perm:[3,3,3,3] row_mask:0xf bank_mask:0xf
  v_mov_b32_dpp v91, v101 quad_perm:[3,3,3,3] row_mask:0xf bank_mask:0xf
  s_nop 0
  v_perm_b32 v91, v91, v75, v68
  v_add_u32_dpp v87, v22, v5 quad_perm:[3,3,3,3] row_mask:0xf bank_mask:0xf
  s_nop 1
  v_mul_f32_dpp v91, v32, v91 quad_perm:[3,3,3,3] row_mask:0xf bank_mask:0xf
  v_cvt_f64_f32 v[82:83], v91
  ds_add_f64 v87, v[82:83]
L_gd_s3_2:
  s_waitcnt lgkmcnt(9)
  v_and_b32 v70, 0x1fffff, v20
  v_ashrrev_i32 v20, 16, v20
  buffer_load_dwordx2 v[98:99], v70, s[12:15], 0 offen
  v_and_b32 v20, 0x8000ffe0, v20
  s_waitcnt vmcnt(1)
  s_waitcnt lgkmcnt(13)
  v_mov_b32_dpp v72, v96 quad_perm:[0,0,0,0] row_mask:0xf bank_mask:0xf
  v_mov_b32_dpp v73, v96 quad_perm:[1,1,1,1] row_mask:0xf bank_mask:0xf
  v_mov_b32_dpp v74, v96 quad_perm:[2,2,2,2] row_mask:0xf bank_mask:0xf
  v_mov_b32_dpp v88, v97 quad_perm:[0,0,0,0] row_mask:0xf bank_mask:0xf
  v_mov_b32_dpp v89, v97 quad_perm:[1,1,1,1] row_mask:0xf bank_mask:0xf
  v_mov_b32_dpp v90, v97 quad_perm:[2,2,2,2] row_mask:0xf bank_mask:0xf
  v_perm_b32 v88, v88, v72, v68
  v_perm_b32 v89, v89, v73, v68
  v_perm_b32 v90, v90, v74, v68
  v_add_u32_dpp v84, v23, v5 quad_perm:[0,0,0,0] row_mask:0xf bank_mask:0xf
  v_add_u32_dpp v85, v23, v5 quad_perm:[1,1,1,1] row_mask:0xf bank_mask:0xf
  v_add_u32_dpp v86, v23, v5 quad_perm:[2,2,2,2] row_mask:0xf bank_mask:0xf
  v_mul_f32_dpp v88, v33, v88 quad_perm:[0,0,0,0] row_mask:0xf bank_mask:0xf
  v_mul_f32_dpp v89, v33, v89 quad_perm:[1,1,1,1] row_mask:0xf bank_mask:0xf
  v_mul_f32_dpp v90, v33, v90 quad_perm:[2,2,2,2] row_mask:0xf bank_mask:0xf
  v_cvt_f64_f32 v[76:77], v88
  v_cvt_f64_f32 v[78:79], v89
  v_cvt_f64_f32 v[80:81], v90
  ds_add_f64 v84, v[76:77]
  ds_add_f64 v85, v[78:79]
  ds_add_f64 v86, v[80:81]
  v_cmp_le_i32 vcc, 0, v23
  s_nop 0
  s_and_b64 vcc, vcc, s[54:55]
  s_cbranch_vccz L_gd_s3_3
  v_mov_b32_dpp v75, v96 quad_perm:[3,3,3,3] row_mask:0xf bank_mask:0xf
  v_mov_b32_dpp v91, v97 quad_perm:[3,3,3,3] row_mask:0xf bank_mask:0xf
  s_nop 0
  v_perm_b32 v91, v91, v75, v68
  v_add_u32_dpp v87, v23, v5 quad_perm:[3,3,3,3] row_mask:0xf bank_mask:0xf
  s_nop 1
  v_mul_f32_dpp v91, v33, v91 quad_perm:[3,3,3,3] row_mask:0xf bank_mask:0xf
  v_cvt_f64_f32 v[82:83], v91
  ds_add_f64 v87, v[82:83]
L_gd_s3_3:
  s_waitcnt lgkmcnt(7)
  v_and_b32 v70, 0x1fffff, v21
  v_ashrrev_i32 v21, 16, v21
  buffer_load_dwordx2 v[100:101], v70, s[12:15], 0 offen
  v_and_b32 v21, 0x8000ffe0, v21
  s_waitcnt vmcnt(1)
  s_waitcnt lgkmcnt(11)
  v_mov_b32_dpp v72, v98 quad_perm:[0,0,0,0] row_mask:0xf bank_mask:0xf
  v_mov_b32_dpp v73, v98 quad_perm:[1,1,1,1] row_mask:0xf bank_mask:0xf
  v_mov_b32_dpp v74, v98 quad_perm:[2,2,2,2] row_mask:0xf bank_mask:0xf
  v_mov_b32_dpp v88, v99 quad_perm:[0,0,0,0] row_mask:0xf bank_mask:0xf
  v_mov_b32_dpp v89, v99 quad_perm:[1,1,1,1] row_mask:0xf bank_mask:0xf
  v_mov_b32_dpp v90, v99 quad_perm:[2,2,2,2] row_mask:0xf bank_mask:0xf
  v_perm_b32 v88, v88, v72, v68
  v_perm_b32 v89, v89, v73, v68
  v_perm_b32 v90, v90, v74, v68
  v_add_u32_dpp v84, v20, v5 quad_perm:[0,0,0,0] row_mask:0xf bank_mask:0xf
  v_add_u32_dpp v85, v20, v5 quad_perm:[1,1,1,1] row_mask:0xf bank_mask:0xf
  v_add_u32_dpp v86, v20, v5 quad_perm:[2,2,2,2] row_mask:0xf bank_mask:0xf
  v_mul_f32_dpp v88, v30, v88 quad_perm:[0,0,0,0] row_mask:0xf bank_mask:0xf
  v_mul_f32_dpp v89, v30, v89 quad_perm:[1,1,1,1] row_mask:0xf bank_mask:0xf
  v_mul_f32_dpp v90, v30, v90 quad_perm:[2,2,2,2] row_mask:0xf bank_mask:0xf
  v_cvt_f64_f32 v[76:77], v88
  v_cvt_f64_f32 v[78:79], v89
  v_cvt_f64_f32 v[80:81], v90
  ds_add_f64 v84, v[76:77]
  ds_add_f64 v85, v[78:79]
  ds_add_f64 v86, v[80:81]
  v_cmp_le_i32 vcc, 0, v20
  s_nop 0
  s_and_b64 vcc, vcc, s[54:55]
  s_cbranch_vccz L_gd_s3_4
  v_mov_b32_dpp v75, v98 quad_perm:[3,3,3,3] row_mask:0xf bank_mask:0xf
  v_mov_b32_dpp v91, v99 quad_perm:[3,3,3,3] row_mask:0xf bank_mask:0xf
  s_nop 0
  v_perm_b32 v91, v91, v75, v68
  v_add_u32_dpp v87, v20, v5 quad_perm:[3,3,3,3] row_mask:0xf bank_mask:0xf
  s_nop 1
  v_mul_f32_dpp v91, v30, v91 quad_perm:[3,3,3,3] row_mask:0xf bank_mask:0xf
  v_cvt_f64_f32 v[82:83], v91
  ds_add_f64 v87, v[82:83]
L_gd_s3_4:
  s_waitcnt vmcnt(0)
  s_waitcnt lgkmcnt(9)
  v_mov_b32_dpp v72, v100 quad_perm:[0,0,0,0] row_mask:0xf bank_mask:0xf
  v_mov_b32_dpp v73, v100 quad_perm:[1,1,1,1] row_mask:0xf bank_mask:0xf
  v_mov_b32_dpp v74, v100 quad_perm:[2,2,2,2] row_mask:0xf bank_mask:0xf
  v_mov_b32_dpp v88, v101 quad_perm:[0,0,0,0] row_mask:0xf bank_mask:0xf
  v_mov_b32_dpp v89, v101 quad_perm:[1,1,1,1] row_mask:0xf bank_mask:0xf
  v_mov_b32_dpp v90, v101 quad_perm:[2,2,2,2] row_mask:0xf bank_mask:0xf
  v_perm_b32 v88, v88, v72, v68
  v_perm_b32 v89, v89, v73, v68
  v_perm_b32 v90, v90, v74, v68
  v_add_u32_dpp v84, v21, v5 quad_perm:[0,0,0,0] row_mask:0xf bank_mask:0xf
  v_add_u32_dpp v85, v21, v5 quad_perm:[1,1,1,1] row_mask:0xf bank_mask:0xf
  v_add_u32_dpp v86, v21, v5 quad_perm:[2,2,2,2] row_mask:0xf bank_mask:0xf
  v_mul_f32_dpp v88, v31, v88 quad_perm:[0,0,0,0] row_mask:0xf bank_mask:0xf
  v_mul_f32_dpp v89, v31, v89 quad_perm:[1,1,1,1] row_mask:0xf bank_mask:0xf
  v_mul_f32_dpp v90, v31, v90 quad_perm:[2,2,2,2] row_mask:0xf bank_mask:0xf
  v_cvt_f64_f32 v[76:77], v88
  v_cvt_f64_f32 v[78:79], v89
  v_cvt_f64_f32 v[80:81], v90
  ds_add_f64 v84, v[76:77]
  ds_add_f64 v85, v[78:79]
  ds_add_f64 v86, v[80:81]
  v_cmp_le_i32 vcc, 0, v21
  s_nop 0
  s_and_b64 vcc, vcc, s[54:55]
  s_cbranch_vccz L_gd_s3_5
  v_mov_b32_dpp v75, v100 quad_perm:[3,3,3,3] row_mask:0xf bank_mask:0xf
  v_mov_b32_dpp v91, v101 quad_perm:[3,3,3,3] row_mask:0xf bank_mask:0xf
  s_nop 0
  v_perm_b32 v91, v91, v75, v68
  v_add_u32_dpp v87, v21, v5 quad_perm:[3,3,3,3] row_mask:0xf bank_mask:0xf
  s_nop 1
  v_mul_f32_dpp v91, v31, v91 quad_perm:[3,3,3,3] row_mask:0xf bank_mask:0xf
  v_cvt_f64_f32 v[82:83], v91
  ds_add_f64 v87, v[82:83]
L_gd_s3_5:
L_final:
  s_waitcnt lgkmcnt(0)
  s_barrier
  s_cmp_lt_u32 s96, 6
  s_cbranch_scc1 L_acc_fin_skip
  v_subrev_u32 v71, 384, v0
  v_lshlrev_b32 v70, 5, v71
  ds_read_b128 v[20:23], v70
  ds_read_b128 v[24:27], v70 offset:16
  s_mul_i32 s97, s2, 5000
  v_lshlrev_b32 v70, 3, v71
  v_lshlrev_b32 v40, 16, v10
  v_and_b32 v41, 0xffff0000, v10
  v_lshlrev_b32 v42, 16, v11
  v_and_b32 v43, 0xffff0000, v11
  v_cmp_gt_u32 vcc, 625, v71
  s_waitcnt lgkmcnt(0)
  v_cvt_f32_f64 v28, v[20:21]
  v_cvt_f32_f64 v29, v[22:23]
  v_cvt_f32_f64 v30, v[24:25]
  v_cvt_f32_f64 v31, v[26:27]
  v_mul_f32 v32, s20, v28
  v_fmac_f32 v32, s24, v29
  v_fmac_f32 v32, s28, v30
  v_fmac_f32 v32, s32, v31
  v_mul_f32 v33, s21, v28
  v_fmac_f32 v33, s25, v29
  v_fmac_f32 v33, s29, v30
  v_fmac_f32 v33, s33, v31
  v_mul_f32 v34, s22, v28
  v_fmac_f32 v34, s26, v29
  v_fmac_f32 v34, s30, v30
  v_fmac_f32 v34, s34, v31
  v_mul_f32 v35, s23, v28
  v_fmac_f32 v35, s27, v29
  v_fmac_f32 v35, s31, v30
  v_fmac_f32 v35, s35, v31
  v_mul_f32 v32, v32, v12
  v_mul_f32 v33, v33, v13
  v_mul_f32 v34, v34, v14
  v_mul_f32 v35, v35, v15
  v_mul_f32 v36, s36, v32
  v_fmac_f32 v36, s40, v33
  v_fmac_f32 v36, s44, v34
  v_fmac_f32 v36, s48, v35
  v_mul_f32 v37, s37, v32
  v_fmac_f32 v37, s41, v33
  v_fmac_f32 v37, s45, v34
  v_fmac_f32 v37, s49, v35
  v_mul_f32 v38, s38, v32
  v_fmac_f32 v38, s42, v33
  v_fmac_f32 v38, s46, v34
  v_fmac_f32 v38, s50, v35
  v_mul_f32 v39, s39, v32
  v_fmac_f32 v39, s43, v33
  v_fmac_f32 v39, s47, v34
  v_fmac_f32 v39, s51, v35
  v_fmac_f32 v40, v36, v16
  v_fmac_f32 v41, v37, v17
  v_fmac_f32 v42, v38, v18
  v_fmac_f32 v43, v39, v19
  v_cvt_pk_bf16_f32 v44, v40, v41
  v_cvt_pk_bf16_f32 v45, v42, v43
  s_mov_b64 exec, vcc
  buffer_store_dwordx2 v[44:45], v70, s[16:19], s97 offen
  s_mov_b64 exec, -1
L_acc_fin_skip:
L_acc_end:
  s_endpgm
.section .rodata,"a"
.p2align 6
.amdhsa_kernel part_kernel
  .amdhsa_next_free_vgpr 76
  .amdhsa_next_free_sgpr 64
  .amdhsa_accum_offset 76
  .amdhsa_group_segment_fixed_size 0
  .amdhsa_kernarg_size 112
  .amdhsa_user_sgpr_count 2
  .amdhsa_user_sgpr_kernarg_segment_ptr 1
  .amdhsa_system_sgpr_workgroup_id_x 1
  .amdhsa_float_denorm_mode_32 3
.end_amdhsa_kernel
.p2align 6
.amdhsa_kernel acc_kernel
  .amdhsa_next_free_vgpr 124
  .amdhsa_next_free_sgpr 102
  .amdhsa_accum_offset 124
  .amdhsa_group_segment_fixed_size 0
  .amdhsa_kernarg_size 112
  .amdhsa_user_sgpr_count 2
  .amdhsa_user_sgpr_kernarg_segment_ptr 1
  .amdhsa_system_sgpr_workgroup_id_x 1
  .amdhsa_float_denorm_mode_32 3
.end_amdhsa_kernel
```
